```python
import torch

def _softmax(x, axis=-1):
    return torch.softmax(x, dim=axis)

def _gelu(x):
    return torch.nn.functional.gelu(x, approximate='tanh')

def _silu(x):
    return torch.nn.functional.silu(x)

def _sigmoid(x):
    return torch.sigmoid(x)

def _layernorm(x, axis=-1, eps=1e-05):
    m = x.mean(dim=axis, keepdim=True)
    v = x.var(dim=axis, keepdim=True, unbiased=False)
    return (x - m) / torch.sqrt(v + eps)

def _scatter_add(tgt, idx, src, axis=0):
    return tgt.clone().index_add_(axis, idx, src)

def _segment_sum(src, seg, n):
    out = torch.zeros((n,) + src.shape[1:], dtype=src.dtype)
    return out.index_add_(0, seg, src)

def _pad(x, pw):
    flat = tuple((v for pair in reversed(pw) for v in pair))
    return torch.nn.functional.pad(x, flat)
kernel_name = 'adaLN_cond__gqa_block_cached__geglu_ffn__decode'

def setup_inputs():

    _w = lambda a: (lambda t: t.to(torch.bfloat16) if t.is_floating_point() else t)(torch.as_tensor(a))

    def _A_setup():
        B, Sq, D = (1, 1, 1024)
        Hq, Hkv, Sk, Dh = (32, 4, 65536, 128)
        assert Hq % Hkv == 0, (Hq, Hkv)
        return {'x': _w((lambda *s: torch.randn(*s, dtype=torch.bfloat16) * 0.05)(B, Sq, D)), 'k_cache': _w((lambda *s: torch.randn(*s, dtype=torch.bfloat16) * 3.2)(B, Hkv, Sk, Dh)), 'v_cache': _w((lambda *s: torch.randn(*s, dtype=torch.bfloat16) * 0.4)(B, Hkv, Sk, Dh)), 'wq': _w((lambda *s: torch.randn(*s, dtype=torch.bfloat16) * 3.2)(D, Hq * Dh) * D ** (-0.5)), 'wo': _w((lambda *s: torch.randn(*s, dtype=torch.bfloat16) * 0.4)(Hq * Dh, D) * (Hq * Dh) ** (-0.5))}
    _A_in = _A_setup()

    def _B_setup():
        B, S, D, F = (1, 1, 1024, 3584)
        return {'x': _w((lambda *s: torch.randn(*s, dtype=torch.bfloat16) * 0.05)(B, S, D)), 'w_gate': _w((lambda *s: torch.randn(*s, dtype=torch.bfloat16) * 0.05)(D, F)), 'w_up': _w((lambda *s: torch.randn(*s, dtype=torch.bfloat16) * 0.05)(D, F)), 'w_down': _w((lambda *s: torch.randn(*s, dtype=torch.bfloat16) * 0.05)(F, D))}
    _B_in = _B_setup()
    return {'A_x': _A_in['x'], 'A_k_cache': _A_in['k_cache'], 'A_v_cache': _A_in['v_cache'], 'A_wq': _A_in['wq'], 'A_wo': _A_in['wo'], 'B_x': _B_in['x'], 'B_w_gate': _B_in['w_gate'], 'B_w_up': _B_in['w_up'], 'B_w_down': _B_in['w_down'], 'c': _w((lambda *s: torch.randn(*s, dtype=torch.bfloat16) * 0.4)(1, 1024) * 8.0), 'w_mod': _w((lambda *s: torch.randn(*s, dtype=torch.bfloat16) * 0.4)(1024, 6 * 1024) * 1024 ** (-0.5) * 8.0)}

def reference(A_x, A_k_cache, A_v_cache, A_wq, A_wo, B_x, B_w_gate, B_w_up, B_w_down, c, w_mod):

    def _A_ref(x, k_cache, v_cache, wq, wo):
        B, Sq, D = x.shape
        Hq, Dh = (32, 128)
        Hkv = k_cache.shape[1]
        rep = Hq // Hkv
        q = (lambda x, *d: x.permute(*d))((x @ wq).reshape(B, Sq, Hq, Dh), 0, 2, 1, 3)
        k = (lambda x, n, axis: torch.repeat_interleave(x, n, dim=axis))(k_cache, rep, axis=1)
        v = (lambda x, n, axis: torch.repeat_interleave(x, n, dim=axis))(v_cache, rep, axis=1)
        scores = torch.einsum('bhqd,bhkd->bhqk', q, k) * Dh ** (-0.5)
        p = _softmax(scores, axis=-1)
        o = torch.einsum('bhqk,bhkd->bhqd', p, v)
        return (lambda x, *d: x.permute(*d))(o, 0, 2, 1, 3).reshape(B, Sq, Hq * Dh) @ wo

    def _B_ref(x, w_gate, w_up, w_down):
        return _gelu(x @ w_gate) * (x @ w_up) @ w_down
    x = A_x
    mod = (_silu(c) @ w_mod).reshape(c.shape[0], 6, 1, -1)
    sa, ca, ga, sb, cb, gb = (mod[:, 0].clone(), mod[:, 1].clone(), mod[:, 2].clone(), mod[:, 3].clone(), mod[:, 4].clone(), mod[:, 5].clone())
    h = _layernorm(x, axis=-1) * (1 + ca) + sa
    x = x + ga * _A_ref(h, A_k_cache, A_v_cache, A_wq, A_wo)
    h = _layernorm(x, axis=-1) * (1 + cb) + sb
    x = x + gb * _B_ref(h, B_w_gate, B_w_up, B_w_down)
    return x
```

```asm
; @launch kernel=k1_mod_kernel grid=(384,1,1) block=(256,1,1) lds=16384
; @launch kernel=k2_q_kernel grid=(256,1,1) block=(256,1,1) lds=16384
; @launch kernel=k3_attn_kernel grid=(256,1,1) block=(256,1,1) lds=67584
; @launch kernel=k4_wo_kernel grid=(256,1,1) block=(256,1,1) lds=16384
; @launch kernel=k5_gu_kernel grid=(224,1,1) block=(256,1,1) lds=16384
; @launch kernel=k6_down_kernel grid=(224,1,1) block=(256,1,1) lds=16384
.amdgcn_target "amdgcn-amd-amdhsa--gfx950"
.text
.p2align 8
.globl k1_mod_kernel
.type k1_mod_kernel,@function
k1_mod_kernel:
    s_cmp_ge_u32 s2, 384
    s_cbranch_scc1 L_end_0
    s_load_dwordx2 s[12:13], s[0:1], 80
    s_load_dwordx2 s[14:15], s[0:1], 104
    s_load_dwordx2 s[16:17], s[0:1], 72
    s_waitcnt lgkmcnt(0)
    s_mov_b32 s4, s12
    s_and_b32 s5, s13, 0xffff
    s_mov_b32 s6, 12582912
    s_mov_b32 s7, 0x00020000
    s_mov_b32 s8, s14
    s_and_b32 s9, s15, 0xffff
    s_mov_b32 s10, 268435456
    s_mov_b32 s11, 0x00020000
    s_mov_b32 s12, s16
    s_and_b32 s13, s17, 0xffff
    s_mov_b32 s14, 2048
    s_mov_b32 s15, 0x00020000
    s_mul_hi_u32 s25, s2, 0x5555556
    s_mul_i32 s26, s25, 48
    s_sub_u32 s26, s2, s26
    s_mul_i32 s20, s25, 1572864
    s_lshl_b32 s27, s26, 8
    s_add_u32 s20, s20, s27
    s_mul_i32 s21, s25, 6144*4
    s_lshl_b32 s27, s26, 9
    s_add_u32 s21, s21, s27
    s_add_u32 s21, s21, 0
    v_lshrrev_b32 v1, 4, v0
    v_and_b32 v2, 15, v0
    s_mov_b32 s22, 12288
    v_mul_lo_u32 v3, v1, s22
    v_lshl_add_u32 v3, v2, 4, v3
    s_mov_b32 s23, s20
    buffer_load_dwordx4 v[16:19], v3, s[4:7], s23 offen nt
    s_add_u32 s23, s23, 196608
    buffer_load_dwordx4 v[20:23], v3, s[4:7], s23 offen nt
    s_add_u32 s23, s23, 196608
    buffer_load_dwordx4 v[24:27], v3, s[4:7], s23 offen nt
    s_add_u32 s23, s23, 196608
    buffer_load_dwordx4 v[28:31], v3, s[4:7], s23 offen nt
    s_add_u32 s23, s23, 196608
    buffer_load_dwordx4 v[32:35], v3, s[4:7], s23 offen nt
    s_add_u32 s23, s23, 196608
    buffer_load_dwordx4 v[36:39], v3, s[4:7], s23 offen nt
    s_add_u32 s23, s23, 196608
    buffer_load_dwordx4 v[40:43], v3, s[4:7], s23 offen nt
    s_add_u32 s23, s23, 196608
    buffer_load_dwordx4 v[44:47], v3, s[4:7], s23 offen nt
    v_cmp_gt_u32 vcc, 128, v0
    s_and_saveexec_b64 s[30:31], vcc
    s_cbranch_execz L_k1_x
    s_mul_i32 s24, s25, 256
    v_lshlrev_b32 v8, 1, v0
    buffer_load_ushort v9, v8, s[12:15], s24 offen
    s_waitcnt vmcnt(0)
    v_lshlrev_b32 v9, 16, v9
    s_mov_b32 s34, 0xbfb8aa3b
    s_mov_b32 s35, 0xb2a57060
    v_mul_f32 v10, s34, v9
    v_fma_f32 v11, s34, v9, -v10
    v_fma_f32 v11, s35, v9, v11
    v_exp_f32 v10, v10
    v_mul_f32 v11, 0x3f317218, v11
    v_fma_f32 v10, v10, v11, v10
    v_add_f32 v10, 1.0, v10
    v_rcp_f32 v11, v10
    s_nop 0
    v_mul_f32 v12, v9, v11
    v_fma_f32 v13, -v12, v10, v9
    v_fma_f32 v9, v13, v11, v12
    v_cvt_pk_bf16_f32 v10, v9, v9
    v_lshlrev_b32 v9, 16, v10
    v_lshlrev_b32 v8, 2, v0
    ds_write_b32 v8, v9
L_k1_x:
    s_mov_b64 exec, s[30:31]
    s_waitcnt lgkmcnt(0)
    s_barrier
    v_lshlrev_b32 v4, 2, v1
    ds_read_b32 v48, v4 offset:0
    ds_read_b32 v49, v4 offset:64
    ds_read_b32 v50, v4 offset:128
    ds_read_b32 v51, v4 offset:192
    ds_read_b32 v52, v4 offset:256
    ds_read_b32 v53, v4 offset:320
    ds_read_b32 v54, v4 offset:384
    ds_read_b32 v55, v4 offset:448
    v_mov_b32 v56, 0
    v_mov_b32 v57, 0
    v_mov_b32 v58, 0
    v_mov_b32 v59, 0
    v_mov_b32 v60, 0
    v_mov_b32 v61, 0
    v_mov_b32 v62, 0
    v_mov_b32 v63, 0
    s_waitcnt lgkmcnt(0)
    s_waitcnt vmcnt(7)
    v_lshlrev_b32 v5, 16, v16
    v_and_b32 v6, 0xffff0000, v16
    v_fmac_f32 v56, v5, v48
    v_fmac_f32 v57, v6, v48
    v_lshlrev_b32 v5, 16, v17
    v_and_b32 v6, 0xffff0000, v17
    v_fmac_f32 v58, v5, v48
    v_fmac_f32 v59, v6, v48
    v_lshlrev_b32 v5, 16, v18
    v_and_b32 v6, 0xffff0000, v18
    v_fmac_f32 v60, v5, v48
    v_fmac_f32 v61, v6, v48
    v_lshlrev_b32 v5, 16, v19
    v_and_b32 v6, 0xffff0000, v19
    v_fmac_f32 v62, v5, v48
    v_fmac_f32 v63, v6, v48
    s_waitcnt vmcnt(6)
    v_lshlrev_b32 v5, 16, v20
    v_and_b32 v6, 0xffff0000, v20
    v_fmac_f32 v56, v5, v49
    v_fmac_f32 v57, v6, v49
    v_lshlrev_b32 v5, 16, v21
    v_and_b32 v6, 0xffff0000, v21
    v_fmac_f32 v58, v5, v49
    v_fmac_f32 v59, v6, v49
    v_lshlrev_b32 v5, 16, v22
    v_and_b32 v6, 0xffff0000, v22
    v_fmac_f32 v60, v5, v49
    v_fmac_f32 v61, v6, v49
    v_lshlrev_b32 v5, 16, v23
    v_and_b32 v6, 0xffff0000, v23
    v_fmac_f32 v62, v5, v49
    v_fmac_f32 v63, v6, v49
    s_waitcnt vmcnt(5)
    v_lshlrev_b32 v5, 16, v24
    v_and_b32 v6, 0xffff0000, v24
    v_fmac_f32 v56, v5, v50
    v_fmac_f32 v57, v6, v50
    v_lshlrev_b32 v5, 16, v25
    v_and_b32 v6, 0xffff0000, v25
    v_fmac_f32 v58, v5, v50
    v_fmac_f32 v59, v6, v50
    v_lshlrev_b32 v5, 16, v26
    v_and_b32 v6, 0xffff0000, v26
    v_fmac_f32 v60, v5, v50
    v_fmac_f32 v61, v6, v50
    v_lshlrev_b32 v5, 16, v27
    v_and_b32 v6, 0xffff0000, v27
    v_fmac_f32 v62, v5, v50
    v_fmac_f32 v63, v6, v50
    s_waitcnt vmcnt(4)
    v_lshlrev_b32 v5, 16, v28
    v_and_b32 v6, 0xffff0000, v28
    v_fmac_f32 v56, v5, v51
    v_fmac_f32 v57, v6, v51
    v_lshlrev_b32 v5, 16, v29
    v_and_b32 v6, 0xffff0000, v29
    v_fmac_f32 v58, v5, v51
    v_fmac_f32 v59, v6, v51
    v_lshlrev_b32 v5, 16, v30
    v_and_b32 v6, 0xffff0000, v30
    v_fmac_f32 v60, v5, v51
    v_fmac_f32 v61, v6, v51
    v_lshlrev_b32 v5, 16, v31
    v_and_b32 v6, 0xffff0000, v31
    v_fmac_f32 v62, v5, v51
    v_fmac_f32 v63, v6, v51
    s_waitcnt vmcnt(3)
    v_lshlrev_b32 v5, 16, v32
    v_and_b32 v6, 0xffff0000, v32
    v_fmac_f32 v56, v5, v52
    v_fmac_f32 v57, v6, v52
    v_lshlrev_b32 v5, 16, v33
    v_and_b32 v6, 0xffff0000, v33
    v_fmac_f32 v58, v5, v52
    v_fmac_f32 v59, v6, v52
    v_lshlrev_b32 v5, 16, v34
    v_and_b32 v6, 0xffff0000, v34
    v_fmac_f32 v60, v5, v52
    v_fmac_f32 v61, v6, v52
    v_lshlrev_b32 v5, 16, v35
    v_and_b32 v6, 0xffff0000, v35
    v_fmac_f32 v62, v5, v52
    v_fmac_f32 v63, v6, v52
    s_waitcnt vmcnt(2)
    v_lshlrev_b32 v5, 16, v36
    v_and_b32 v6, 0xffff0000, v36
    v_fmac_f32 v56, v5, v53
    v_fmac_f32 v57, v6, v53
    v_lshlrev_b32 v5, 16, v37
    v_and_b32 v6, 0xffff0000, v37
    v_fmac_f32 v58, v5, v53
    v_fmac_f32 v59, v6, v53
    v_lshlrev_b32 v5, 16, v38
    v_and_b32 v6, 0xffff0000, v38
    v_fmac_f32 v60, v5, v53
    v_fmac_f32 v61, v6, v53
    v_lshlrev_b32 v5, 16, v39
    v_and_b32 v6, 0xffff0000, v39
    v_fmac_f32 v62, v5, v53
    v_fmac_f32 v63, v6, v53
    s_waitcnt vmcnt(1)
    v_lshlrev_b32 v5, 16, v40
    v_and_b32 v6, 0xffff0000, v40
    v_fmac_f32 v56, v5, v54
    v_fmac_f32 v57, v6, v54
    v_lshlrev_b32 v5, 16, v41
    v_and_b32 v6, 0xffff0000, v41
    v_fmac_f32 v58, v5, v54
    v_fmac_f32 v59, v6, v54
    v_lshlrev_b32 v5, 16, v42
    v_and_b32 v6, 0xffff0000, v42
    v_fmac_f32 v60, v5, v54
    v_fmac_f32 v61, v6, v54
    v_lshlrev_b32 v5, 16, v43
    v_and_b32 v6, 0xffff0000, v43
    v_fmac_f32 v62, v5, v54
    v_fmac_f32 v63, v6, v54
    s_waitcnt vmcnt(0)
    v_lshlrev_b32 v5, 16, v44
    v_and_b32 v6, 0xffff0000, v44
    v_fmac_f32 v56, v5, v55
    v_fmac_f32 v57, v6, v55
    v_lshlrev_b32 v5, 16, v45
    v_and_b32 v6, 0xffff0000, v45
    v_fmac_f32 v58, v5, v55
    v_fmac_f32 v59, v6, v55
    v_lshlrev_b32 v5, 16, v46
    v_and_b32 v6, 0xffff0000, v46
    v_fmac_f32 v60, v5, v55
    v_fmac_f32 v61, v6, v55
    v_lshlrev_b32 v5, 16, v47
    v_and_b32 v6, 0xffff0000, v47
    v_fmac_f32 v62, v5, v55
    v_fmac_f32 v63, v6, v55
    v_lshlrev_b32 v4, 9, v1
    v_lshl_add_u32 v4, v2, 5, v4
    ds_write_b128 v4, v[56:59] offset:4096
    ds_write_b128 v4, v[60:63] offset:4112
    s_waitcnt lgkmcnt(0)
    s_barrier
    v_cmp_gt_u32 vcc, 128, v0
    s_and_saveexec_b64 s[30:31], vcc
    s_cbranch_execz L_245
    v_lshlrev_b32 v4, 2, v0
    ds_read_b32 v16, v4 offset:4096
    ds_read_b32 v17, v4 offset:4608
    ds_read_b32 v18, v4 offset:5120
    ds_read_b32 v19, v4 offset:5632
    ds_read_b32 v20, v4 offset:6144
    ds_read_b32 v21, v4 offset:6656
    ds_read_b32 v22, v4 offset:7168
    ds_read_b32 v23, v4 offset:7680
    ds_read_b32 v24, v4 offset:8192
    ds_read_b32 v25, v4 offset:8704
    ds_read_b32 v26, v4 offset:9216
    ds_read_b32 v27, v4 offset:9728
    ds_read_b32 v28, v4 offset:10240
    ds_read_b32 v29, v4 offset:10752
    ds_read_b32 v30, v4 offset:11264
    ds_read_b32 v31, v4 offset:11776
    s_waitcnt lgkmcnt(0)
    v_add_f32 v16, v16, v17
    v_add_f32 v16, v16, v18
    v_add_f32 v16, v16, v19
    v_add_f32 v16, v16, v20
    v_add_f32 v16, v16, v21
    v_add_f32 v16, v16, v22
    v_add_f32 v16, v16, v23
    v_add_f32 v16, v16, v24
    v_add_f32 v16, v16, v25
    v_add_f32 v16, v16, v26
    v_add_f32 v16, v16, v27
    v_add_f32 v16, v16, v28
    v_add_f32 v16, v16, v29
    v_add_f32 v16, v16, v30
    v_add_f32 v16, v16, v31
    buffer_store_dword v16, v4, s[8:11], s21 offen sc0 sc1
L_245:
    s_mov_b64 exec, s[30:31]
L_end_0:
    s_endpgm
.p2align 8
.globl k2_q_kernel
.type k2_q_kernel,@function
k2_q_kernel:
    s_cmp_ge_u32 s2, 256
    s_cbranch_scc1 L_end_1
    s_load_dwordx2 s[12:13], s[0:1], 24
    s_load_dwordx2 s[14:15], s[0:1], 104
    s_load_dwordx2 s[16:17], s[0:1], 0
    s_waitcnt lgkmcnt(0)
    s_mov_b32 s4, s12
    s_and_b32 s5, s13, 0xffff
    s_mov_b32 s6, 8388608
    s_mov_b32 s7, 0x00020000
    s_mov_b32 s8, s14
    s_and_b32 s9, s15, 0xffff
    s_mov_b32 s10, 268435456
    s_mov_b32 s11, 0x00020000
    s_mov_b32 s12, s16
    s_and_b32 s13, s17, 0xffff
    s_mov_b32 s14, 2048
    s_mov_b32 s15, 0x00020000
    s_lshr_b32 s25, s2, 5
    s_and_b32 s26, s2, 31
    s_mul_i32 s20, s25, 1048576
    s_lshl_b32 s27, s26, 8
    s_add_u32 s20, s20, s27
    s_mul_i32 s21, s25, 4096*4
    s_lshl_b32 s27, s26, 9
    s_add_u32 s21, s21, s27
    s_add_u32 s21, s21, 196608
    v_lshrrev_b32 v1, 4, v0
    v_and_b32 v2, 15, v0
    s_mov_b32 s22, 8192
    v_mul_lo_u32 v3, v1, s22
    v_lshl_add_u32 v3, v2, 4, v3
    s_mov_b32 s23, s20
    buffer_load_dwordx4 v[16:19], v3, s[4:7], s23 offen nt
    s_add_u32 s23, s23, 131072
    buffer_load_dwordx4 v[20:23], v3, s[4:7], s23 offen nt
    s_add_u32 s23, s23, 131072
    buffer_load_dwordx4 v[24:27], v3, s[4:7], s23 offen nt
    s_add_u32 s23, s23, 131072
    buffer_load_dwordx4 v[28:31], v3, s[4:7], s23 offen nt
    s_add_u32 s23, s23, 131072
    buffer_load_dwordx4 v[32:35], v3, s[4:7], s23 offen nt
    s_add_u32 s23, s23, 131072
    buffer_load_dwordx4 v[36:39], v3, s[4:7], s23 offen nt
    s_add_u32 s23, s23, 131072
    buffer_load_dwordx4 v[40:43], v3, s[4:7], s23 offen nt
    s_add_u32 s23, s23, 131072
    buffer_load_dwordx4 v[44:47], v3, s[4:7], s23 offen nt
    v_lshlrev_b32 v8, 3, v0
    buffer_load_dwordx2 v[10:11], v8, s[12:15], 0 offen
    v_and_b32 v7, 63, v0
    v_lshlrev_b32 v7, 2, v7
    s_waitcnt vmcnt(0)
    v_and_b32 v13, 0xffff0000, v11
    v_lshlrev_b32 v12, 16, v11
    v_and_b32 v11, 0xffff0000, v10
    v_lshlrev_b32 v10, 16, v10
    v_add_f32 v102, v10, v11
    v_add_f32 v103, v12, v13
    v_add_f32 v14, v102, v103
    v_xor_b32 v100, 4, v7
    ds_bpermute_b32 v101, v100, v14
    s_waitcnt lgkmcnt(0)
    v_add_f32 v14, v14, v101
    v_xor_b32 v100, 8, v7
    ds_bpermute_b32 v101, v100, v14
    s_waitcnt lgkmcnt(0)
    v_add_f32 v14, v14, v101
    v_xor_b32 v100, 16, v7
    ds_bpermute_b32 v101, v100, v14
    s_waitcnt lgkmcnt(0)
    v_add_f32 v14, v14, v101
    v_xor_b32 v100, 32, v7
    ds_bpermute_b32 v101, v100, v14
    s_waitcnt lgkmcnt(0)
    v_add_f32 v14, v14, v101
    v_xor_b32 v100, 64, v7
    ds_bpermute_b32 v101, v100, v14
    s_waitcnt lgkmcnt(0)
    v_add_f32 v14, v14, v101
    v_xor_b32 v100, 128, v7
    ds_bpermute_b32 v101, v100, v14
    s_waitcnt lgkmcnt(0)
    v_add_f32 v14, v14, v101
    v_lshrrev_b32 v100, 6, v0
    v_lshlrev_b32 v100, 2, v100
    ds_write_b32 v100, v14 offset:2048
    s_waitcnt lgkmcnt(0)
    s_barrier
    v_mov_b32 v100, 0
    ds_read_b128 v[104:107], v100 offset:2048
    s_waitcnt lgkmcnt(0)
    v_add_f32 v14, v104, v105
    v_add_f32 v14, v14, v106
    v_add_f32 v14, v14, v107
    v_mul_f32 v14, 0x3a800000, v14
    v_mov_b32 v15, 0
    v_sub_f32 v102, v10, v14
    v_fmac_f32 v15, v102, v102
    v_sub_f32 v102, v11, v14
    v_fmac_f32 v15, v102, v102
    v_sub_f32 v102, v12, v14
    v_fmac_f32 v15, v102, v102
    v_sub_f32 v102, v13, v14
    v_fmac_f32 v15, v102, v102
    v_xor_b32 v100, 4, v7
    ds_bpermute_b32 v101, v100, v15
    s_waitcnt lgkmcnt(0)
    v_add_f32 v15, v15, v101
    v_xor_b32 v100, 8, v7
    ds_bpermute_b32 v101, v100, v15
    s_waitcnt lgkmcnt(0)
    v_add_f32 v15, v15, v101
    v_xor_b32 v100, 16, v7
    ds_bpermute_b32 v101, v100, v15
    s_waitcnt lgkmcnt(0)
    v_add_f32 v15, v15, v101
    v_xor_b32 v100, 32, v7
    ds_bpermute_b32 v101, v100, v15
    s_waitcnt lgkmcnt(0)
    v_add_f32 v15, v15, v101
    v_xor_b32 v100, 64, v7
    ds_bpermute_b32 v101, v100, v15
    s_waitcnt lgkmcnt(0)
    v_add_f32 v15, v15, v101
    v_xor_b32 v100, 128, v7
    ds_bpermute_b32 v101, v100, v15
    s_waitcnt lgkmcnt(0)
    v_add_f32 v15, v15, v101
    v_lshrrev_b32 v100, 6, v0
    v_lshlrev_b32 v100, 2, v100
    ds_write_b32 v100, v15 offset:2064
    s_waitcnt lgkmcnt(0)
    s_barrier
    v_mov_b32 v100, 0
    ds_read_b128 v[104:107], v100 offset:2064
    s_waitcnt lgkmcnt(0)
    v_add_f32 v15, v104, v105
    v_add_f32 v15, v15, v106
    v_add_f32 v15, v15, v107
    v_mul_f32 v15, 0x3a800000, v15
    v_cvt_pk_bf16_f32 v100, v15, v15
    v_lshlrev_b32 v15, 16, v100
    v_add_f32 v15, 0x3727c5ac, v15
    v_cvt_pk_bf16_f32 v100, v15, v15
    v_lshlrev_b32 v15, 16, v100
    v_sqrt_f32 v15, v15
    s_nop 0
    v_cvt_pk_bf16_f32 v100, v15, v15
    v_lshlrev_b32 v15, 16, v100
    v_cvt_pk_bf16_f32 v100, v14, v14
    v_lshlrev_b32 v14, 16, v100
    v_cmp_gt_u32 vcc, 128, v0
    s_and_saveexec_b64 s[30:31], vcc
    s_cbranch_execz L_k2_x
    s_mul_i32 s24, s25, 256
    v_lshlrev_b32 v8, 1, v0
    buffer_load_ushort v9, v8, s[12:15], s24 offen
    s_mul_i32 s28, s25, 512
    v_lshlrev_b32 v8, 2, v0
    v_add_u32 v8, s28, v8
    s_mov_b32 s24, 0
    buffer_load_dword v60, v8, s[8:11], s24 offen sc0 sc1
    s_mov_b32 s24, 24576
    buffer_load_dword v61, v8, s[8:11], s24 offen sc0 sc1
    s_mov_b32 s24, 49152
    buffer_load_dword v62, v8, s[8:11], s24 offen sc0 sc1
    s_mov_b32 s24, 73728
    buffer_load_dword v63, v8, s[8:11], s24 offen sc0 sc1
    s_mov_b32 s24, 98304
    buffer_load_dword v64, v8, s[8:11], s24 offen sc0 sc1
    s_mov_b32 s24, 122880
    buffer_load_dword v65, v8, s[8:11], s24 offen sc0 sc1
    s_mov_b32 s24, 147456
    buffer_load_dword v66, v8, s[8:11], s24 offen sc0 sc1
    s_mov_b32 s24, 172032
    buffer_load_dword v67, v8, s[8:11], s24 offen sc0 sc1
    s_waitcnt vmcnt(0)
    v_mov_b32 v104, v60
    v_add_f32 v104, v104, v61
    v_add_f32 v104, v104, v62
    v_add_f32 v104, v104, v63
    v_add_f32 v104, v104, v64
    v_add_f32 v104, v104, v65
    v_add_f32 v104, v104, v66
    v_add_f32 v104, v104, v67
    s_mov_b32 s24, 4096
    buffer_load_dword v60, v8, s[8:11], s24 offen sc0 sc1
    s_mov_b32 s24, 28672
    buffer_load_dword v61, v8, s[8:11], s24 offen sc0 sc1
    s_mov_b32 s24, 53248
    buffer_load_dword v62, v8, s[8:11], s24 offen sc0 sc1
    s_mov_b32 s24, 77824
    buffer_load_dword v63, v8, s[8:11], s24 offen sc0 sc1
    s_mov_b32 s24, 102400
    buffer_load_dword v64, v8, s[8:11], s24 offen sc0 sc1
    s_mov_b32 s24, 126976
    buffer_load_dword v65, v8, s[8:11], s24 offen sc0 sc1
    s_mov_b32 s24, 151552
    buffer_load_dword v66, v8, s[8:11], s24 offen sc0 sc1
    s_mov_b32 s24, 176128
    buffer_load_dword v67, v8, s[8:11], s24 offen sc0 sc1
    s_waitcnt vmcnt(0)
    v_mov_b32 v105, v60
    v_add_f32 v105, v105, v61
    v_add_f32 v105, v105, v62
    v_add_f32 v105, v105, v63
    v_add_f32 v105, v105, v64
    v_add_f32 v105, v105, v65
    v_add_f32 v105, v105, v66
    v_add_f32 v105, v105, v67
    v_cvt_pk_bf16_f32 v100, v104, v104
    v_lshlrev_b32 v104, 16, v100
    v_cvt_pk_bf16_f32 v100, v105, v105
    v_lshlrev_b32 v105, 16, v100
    v_lshlrev_b32 v9, 16, v9
    v_sub_f32 v9, v9, v14
    v_cvt_pk_bf16_f32 v100, v9, v9
    v_lshlrev_b32 v9, 16, v100
    v_rcp_f32 v101, v15
    s_nop 0
    v_mul_f32 v102, v9, v101
    v_fma_f32 v103, -v102, v15, v9
    v_fma_f32 v9, v103, v101, v102
    v_cvt_pk_bf16_f32 v100, v9, v9
    v_lshlrev_b32 v9, 16, v100
    v_add_f32 v105, 1.0, v105
    v_cvt_pk_bf16_f32 v100, v105, v105
    v_lshlrev_b32 v105, 16, v100
    v_mul_f32 v9, v9, v105
    v_cvt_pk_bf16_f32 v100, v9, v9
    v_lshlrev_b32 v9, 16, v100
    v_add_f32 v9, v9, v104
    v_cvt_pk_bf16_f32 v100, v9, v9
    v_lshlrev_b32 v9, 16, v100
    v_lshlrev_b32 v8, 2, v0
    ds_write_b32 v8, v9
L_k2_x:
    s_mov_b64 exec, s[30:31]
    s_waitcnt lgkmcnt(0)
    s_barrier
    v_lshlrev_b32 v4, 2, v1
    ds_read_b32 v48, v4 offset:0
    ds_read_b32 v49, v4 offset:64
    ds_read_b32 v50, v4 offset:128
    ds_read_b32 v51, v4 offset:192
    ds_read_b32 v52, v4 offset:256
    ds_read_b32 v53, v4 offset:320
    ds_read_b32 v54, v4 offset:384
    ds_read_b32 v55, v4 offset:448
    v_mov_b32 v56, 0
    v_mov_b32 v57, 0
    v_mov_b32 v58, 0
    v_mov_b32 v59, 0
    v_mov_b32 v60, 0
    v_mov_b32 v61, 0
    v_mov_b32 v62, 0
    v_mov_b32 v63, 0
    s_waitcnt lgkmcnt(0)
    s_waitcnt vmcnt(7)
    v_lshlrev_b32 v5, 16, v16
    v_and_b32 v6, 0xffff0000, v16
    v_fmac_f32 v56, v5, v48
    v_fmac_f32 v57, v6, v48
    v_lshlrev_b32 v5, 16, v17
    v_and_b32 v6, 0xffff0000, v17
    v_fmac_f32 v58, v5, v48
    v_fmac_f32 v59, v6, v48
    v_lshlrev_b32 v5, 16, v18
    v_and_b32 v6, 0xffff0000, v18
    v_fmac_f32 v60, v5, v48
    v_fmac_f32 v61, v6, v48
    v_lshlrev_b32 v5, 16, v19
    v_and_b32 v6, 0xffff0000, v19
    v_fmac_f32 v62, v5, v48
    v_fmac_f32 v63, v6, v48
    s_waitcnt vmcnt(6)
    v_lshlrev_b32 v5, 16, v20
    v_and_b32 v6, 0xffff0000, v20
    v_fmac_f32 v56, v5, v49
    v_fmac_f32 v57, v6, v49
    v_lshlrev_b32 v5, 16, v21
    v_and_b32 v6, 0xffff0000, v21
    v_fmac_f32 v58, v5, v49
    v_fmac_f32 v59, v6, v49
    v_lshlrev_b32 v5, 16, v22
    v_and_b32 v6, 0xffff0000, v22
    v_fmac_f32 v60, v5, v49
    v_fmac_f32 v61, v6, v49
    v_lshlrev_b32 v5, 16, v23
    v_and_b32 v6, 0xffff0000, v23
    v_fmac_f32 v62, v5, v49
    v_fmac_f32 v63, v6, v49
    s_waitcnt vmcnt(5)
    v_lshlrev_b32 v5, 16, v24
    v_and_b32 v6, 0xffff0000, v24
    v_fmac_f32 v56, v5, v50
    v_fmac_f32 v57, v6, v50
    v_lshlrev_b32 v5, 16, v25
    v_and_b32 v6, 0xffff0000, v25
    v_fmac_f32 v58, v5, v50
    v_fmac_f32 v59, v6, v50
    v_lshlrev_b32 v5, 16, v26
    v_and_b32 v6, 0xffff0000, v26
    v_fmac_f32 v60, v5, v50
    v_fmac_f32 v61, v6, v50
    v_lshlrev_b32 v5, 16, v27
    v_and_b32 v6, 0xffff0000, v27
    v_fmac_f32 v62, v5, v50
    v_fmac_f32 v63, v6, v50
    s_waitcnt vmcnt(4)
    v_lshlrev_b32 v5, 16, v28
    v_and_b32 v6, 0xffff0000, v28
    v_fmac_f32 v56, v5, v51
    v_fmac_f32 v57, v6, v51
    v_lshlrev_b32 v5, 16, v29
    v_and_b32 v6, 0xffff0000, v29
    v_fmac_f32 v58, v5, v51
    v_fmac_f32 v59, v6, v51
    v_lshlrev_b32 v5, 16, v30
    v_and_b32 v6, 0xffff0000, v30
    v_fmac_f32 v60, v5, v51
    v_fmac_f32 v61, v6, v51
    v_lshlrev_b32 v5, 16, v31
    v_and_b32 v6, 0xffff0000, v31
    v_fmac_f32 v62, v5, v51
    v_fmac_f32 v63, v6, v51
    s_waitcnt vmcnt(3)
    v_lshlrev_b32 v5, 16, v32
    v_and_b32 v6, 0xffff0000, v32
    v_fmac_f32 v56, v5, v52
    v_fmac_f32 v57, v6, v52
    v_lshlrev_b32 v5, 16, v33
    v_and_b32 v6, 0xffff0000, v33
    v_fmac_f32 v58, v5, v52
    v_fmac_f32 v59, v6, v52
    v_lshlrev_b32 v5, 16, v34
    v_and_b32 v6, 0xffff0000, v34
    v_fmac_f32 v60, v5, v52
    v_fmac_f32 v61, v6, v52
    v_lshlrev_b32 v5, 16, v35
    v_and_b32 v6, 0xffff0000, v35
    v_fmac_f32 v62, v5, v52
    v_fmac_f32 v63, v6, v52
    s_waitcnt vmcnt(2)
    v_lshlrev_b32 v5, 16, v36
    v_and_b32 v6, 0xffff0000, v36
    v_fmac_f32 v56, v5, v53
    v_fmac_f32 v57, v6, v53
    v_lshlrev_b32 v5, 16, v37
    v_and_b32 v6, 0xffff0000, v37
    v_fmac_f32 v58, v5, v53
    v_fmac_f32 v59, v6, v53
    v_lshlrev_b32 v5, 16, v38
    v_and_b32 v6, 0xffff0000, v38
    v_fmac_f32 v60, v5, v53
    v_fmac_f32 v61, v6, v53
    v_lshlrev_b32 v5, 16, v39
    v_and_b32 v6, 0xffff0000, v39
    v_fmac_f32 v62, v5, v53
    v_fmac_f32 v63, v6, v53
    s_waitcnt vmcnt(1)
    v_lshlrev_b32 v5, 16, v40
    v_and_b32 v6, 0xffff0000, v40
    v_fmac_f32 v56, v5, v54
    v_fmac_f32 v57, v6, v54
    v_lshlrev_b32 v5, 16, v41
    v_and_b32 v6, 0xffff0000, v41
    v_fmac_f32 v58, v5, v54
    v_fmac_f32 v59, v6, v54
    v_lshlrev_b32 v5, 16, v42
    v_and_b32 v6, 0xffff0000, v42
    v_fmac_f32 v60, v5, v54
    v_fmac_f32 v61, v6, v54
    v_lshlrev_b32 v5, 16, v43
    v_and_b32 v6, 0xffff0000, v43
    v_fmac_f32 v62, v5, v54
    v_fmac_f32 v63, v6, v54
    s_waitcnt vmcnt(0)
    v_lshlrev_b32 v5, 16, v44
    v_and_b32 v6, 0xffff0000, v44
    v_fmac_f32 v56, v5, v55
    v_fmac_f32 v57, v6, v55
    v_lshlrev_b32 v5, 16, v45
    v_and_b32 v6, 0xffff0000, v45
    v_fmac_f32 v58, v5, v55
    v_fmac_f32 v59, v6, v55
    v_lshlrev_b32 v5, 16, v46
    v_and_b32 v6, 0xffff0000, v46
    v_fmac_f32 v60, v5, v55
    v_fmac_f32 v61, v6, v55
    v_lshlrev_b32 v5, 16, v47
    v_and_b32 v6, 0xffff0000, v47
    v_fmac_f32 v62, v5, v55
    v_fmac_f32 v63, v6, v55
    v_lshlrev_b32 v4, 9, v1
    v_lshl_add_u32 v4, v2, 5, v4
    ds_write_b128 v4, v[56:59] offset:4096
    ds_write_b128 v4, v[60:63] offset:4112
    s_waitcnt lgkmcnt(0)
    s_barrier
    v_cmp_gt_u32 vcc, 128, v0
    s_and_saveexec_b64 s[30:31], vcc
    s_cbranch_execz L_691
    v_lshlrev_b32 v4, 2, v0
    ds_read_b32 v16, v4 offset:4096
    ds_read_b32 v17, v4 offset:4608
    ds_read_b32 v18, v4 offset:5120
    ds_read_b32 v19, v4 offset:5632
    ds_read_b32 v20, v4 offset:6144
    ds_read_b32 v21, v4 offset:6656
    ds_read_b32 v22, v4 offset:7168
    ds_read_b32 v23, v4 offset:7680
    ds_read_b32 v24, v4 offset:8192
    ds_read_b32 v25, v4 offset:8704
    ds_read_b32 v26, v4 offset:9216
    ds_read_b32 v27, v4 offset:9728
    ds_read_b32 v28, v4 offset:10240
    ds_read_b32 v29, v4 offset:10752
    ds_read_b32 v30, v4 offset:11264
    ds_read_b32 v31, v4 offset:11776
    s_waitcnt lgkmcnt(0)
    v_add_f32 v16, v16, v17
    v_add_f32 v16, v16, v18
    v_add_f32 v16, v16, v19
    v_add_f32 v16, v16, v20
    v_add_f32 v16, v16, v21
    v_add_f32 v16, v16, v22
    v_add_f32 v16, v16, v23
    v_add_f32 v16, v16, v24
    v_add_f32 v16, v16, v25
    v_add_f32 v16, v16, v26
    v_add_f32 v16, v16, v27
    v_add_f32 v16, v16, v28
    v_add_f32 v16, v16, v29
    v_add_f32 v16, v16, v30
    v_add_f32 v16, v16, v31
    buffer_store_dword v16, v4, s[8:11], s21 offen sc0 sc1
L_691:
    s_mov_b64 exec, s[30:31]
L_end_1:
    s_endpgm
.p2align 8
.globl k3_attn_kernel
.type k3_attn_kernel,@function
k3_attn_kernel:
    s_cmp_ge_u32 s2, 256
    s_cbranch_scc1 L_end_2
    s_load_dwordx2 s[12:13], s[0:1], 8
    s_load_dwordx2 s[14:15], s[0:1], 16
    s_load_dwordx2 s[16:17], s[0:1], 104
    s_waitcnt lgkmcnt(0)
    s_mov_b32 s4, s12
    s_and_b32 s5, s13, 0xffff
    s_mov_b32 s6, 67108864
    s_mov_b32 s7, 0x00020000
    s_mov_b32 s24, s14
    s_and_b32 s25, s15, 0xffff
    s_mov_b32 s26, 67108864
    s_mov_b32 s27, 0x00020000
    s_mov_b32 s8, s16
    s_and_b32 s9, s17, 0xffff
    s_mov_b32 s10, 268435456
    s_mov_b32 s11, 0x00020000
    s_lshr_b32 s20, s2, 6
    s_and_b32 s21, s2, 63
    v_lshrrev_b32 v1, 6, v0
    v_and_b32 v2, 63, v0
    v_and_b32 v3, 15, v2
    v_lshrrev_b32 v4, 4, v2
    v_readfirstlane_b32 s22, v1
    s_lshl_b32 s23, s20, 24
    s_lshl_b32 s28, s21, 18
    s_add_u32 s23, s23, s28
    s_lshl_b32 s28, s22, 16
    s_add_u32 s23, s23, s28
    v_lshlrev_b32 v5, 8, v3
    v_lshl_add_u32 v5, v4, 4, v5
    v_lshlrev_b32 v6, 8, v4
    v_lshl_add_u32 v6, v3, 4, v6
    s_lshl_b32 s29, s22, 14
    s_add_u32 s29, s29, 2048
    s_add_u32 s30, s23, 0
    s_add_u32 s31, s30, 4096
    buffer_load_dwordx4 v[40:43], v5, s[4:7], s30 offen offset:0 nt
    buffer_load_dwordx4 v[44:47], v5, s[4:7], s30 offen offset:64 nt
    buffer_load_dwordx4 v[48:51], v5, s[4:7], s30 offen offset:128 nt
    buffer_load_dwordx4 v[52:55], v5, s[4:7], s30 offen offset:192 nt
    buffer_load_dwordx4 v[56:59], v5, s[4:7], s31 offen offset:0 nt
    buffer_load_dwordx4 v[60:63], v5, s[4:7], s31 offen offset:64 nt
    buffer_load_dwordx4 v[64:67], v5, s[4:7], s31 offen offset:128 nt
    buffer_load_dwordx4 v[68:71], v5, s[4:7], s31 offen offset:192 nt
    s_add_u32 s32, s29, 0
    s_mov_b32 m0, s32
    s_nop 0
    buffer_load_dwordx4 v6, s[24:27], s30 offen offset:0 lds
    buffer_load_dwordx4 v6, s[24:27], s30 offen offset:1024 lds
    buffer_load_dwordx4 v6, s[24:27], s30 offen offset:2048 lds
    buffer_load_dwordx4 v6, s[24:27], s30 offen offset:3072 lds
    s_add_u32 s32, s29, 4096
    s_mov_b32 m0, s32
    s_nop 0
    buffer_load_dwordx4 v6, s[24:27], s31 offen offset:0 lds
    buffer_load_dwordx4 v6, s[24:27], s31 offen offset:1024 lds
    buffer_load_dwordx4 v6, s[24:27], s31 offen offset:2048 lds
    buffer_load_dwordx4 v6, s[24:27], s31 offen offset:3072 lds
    s_add_u32 s30, s23, 8192
    s_add_u32 s31, s30, 4096
    buffer_load_dwordx4 v[72:75], v5, s[4:7], s30 offen offset:0 nt
    buffer_load_dwordx4 v[76:79], v5, s[4:7], s30 offen offset:64 nt
    buffer_load_dwordx4 v[80:83], v5, s[4:7], s30 offen offset:128 nt
    buffer_load_dwordx4 v[84:87], v5, s[4:7], s30 offen offset:192 nt
    buffer_load_dwordx4 v[88:91], v5, s[4:7], s31 offen offset:0 nt
    buffer_load_dwordx4 v[92:95], v5, s[4:7], s31 offen offset:64 nt
    buffer_load_dwordx4 v[96:99], v5, s[4:7], s31 offen offset:128 nt
    buffer_load_dwordx4 v[100:103], v5, s[4:7], s31 offen offset:192 nt
    s_add_u32 s32, s29, 8192
    s_mov_b32 m0, s32
    s_nop 0
    buffer_load_dwordx4 v6, s[24:27], s30 offen offset:0 lds
    buffer_load_dwordx4 v6, s[24:27], s30 offen offset:1024 lds
    buffer_load_dwordx4 v6, s[24:27], s30 offen offset:2048 lds
    buffer_load_dwordx4 v6, s[24:27], s30 offen offset:3072 lds
    s_add_u32 s32, s29, 12288
    s_mov_b32 m0, s32
    s_nop 0
    buffer_load_dwordx4 v6, s[24:27], s31 offen offset:0 lds
    buffer_load_dwordx4 v6, s[24:27], s31 offen offset:1024 lds
    buffer_load_dwordx4 v6, s[24:27], s31 offen offset:2048 lds
    buffer_load_dwordx4 v6, s[24:27], s31 offen offset:3072 lds
    s_lshl_b32 s28, s20, 12
    v_lshlrev_b32 v7, 4, v0
    v_add_u32 v7, s28, v7
    s_mov_b32 s33, 196608
    buffer_load_dwordx4 v[104:107], v7, s[8:11], s33 offen sc0 sc1
    s_mov_b32 s33, 212992
    buffer_load_dwordx4 v[108:111], v7, s[8:11], s33 offen sc0 sc1
    s_mov_b32 s33, 229376
    buffer_load_dwordx4 v[112:115], v7, s[8:11], s33 offen sc0 sc1
    s_mov_b32 s33, 245760
    buffer_load_dwordx4 v[116:119], v7, s[8:11], s33 offen sc0 sc1
    s_mov_b32 s33, 262144
    buffer_load_dwordx4 v[120:123], v7, s[8:11], s33 offen sc0 sc1
    s_mov_b32 s33, 278528
    buffer_load_dwordx4 v[124:127], v7, s[8:11], s33 offen sc0 sc1
    s_mov_b32 s33, 294912
    buffer_load_dwordx4 v[128:131], v7, s[8:11], s33 offen sc0 sc1
    s_mov_b32 s33, 311296
    buffer_load_dwordx4 v[132:135], v7, s[8:11], s33 offen sc0 sc1
    s_waitcnt vmcnt(0)
    v_add_f32 v104, v104, v108
    v_add_f32 v105, v105, v109
    v_add_f32 v106, v106, v110
    v_add_f32 v107, v107, v111
    v_add_f32 v104, v104, v112
    v_add_f32 v105, v105, v113
    v_add_f32 v106, v106, v114
    v_add_f32 v107, v107, v115
    v_add_f32 v104, v104, v116
    v_add_f32 v105, v105, v117
    v_add_f32 v106, v106, v118
    v_add_f32 v107, v107, v119
    v_add_f32 v104, v104, v120
    v_add_f32 v105, v105, v121
    v_add_f32 v106, v106, v122
    v_add_f32 v107, v107, v123
    v_add_f32 v104, v104, v124
    v_add_f32 v105, v105, v125
    v_add_f32 v106, v106, v126
    v_add_f32 v107, v107, v127
    v_add_f32 v104, v104, v128
    v_add_f32 v105, v105, v129
    v_add_f32 v106, v106, v130
    v_add_f32 v107, v107, v131
    v_add_f32 v104, v104, v132
    v_add_f32 v105, v105, v133
    v_add_f32 v106, v106, v134
    v_add_f32 v107, v107, v135
    v_cvt_pk_bf16_f32 v104, v104, v105
    v_cvt_pk_bf16_f32 v105, v106, v107
    v_lshlrev_b32 v7, 3, v0
    ds_write_b64 v7, v[104:105] offset:0
    s_waitcnt lgkmcnt(0)
    s_barrier
    v_lshlrev_b32 v7, 8, v3
    v_lshl_add_u32 v7, v4, 4, v7
    ds_read_b128 v[24:27], v7 offset:0
    ds_read_b128 v[28:31], v7 offset:64
    ds_read_b128 v[32:35], v7 offset:128
    ds_read_b128 v[36:39], v7 offset:192
    v_cmp_gt_u32 vcc, 8, v3
    s_waitcnt lgkmcnt(0)
    v_cndmask_b32 v24, 0, v24, vcc
    v_cndmask_b32 v25, 0, v25, vcc
    v_cndmask_b32 v26, 0, v26, vcc
    v_cndmask_b32 v27, 0, v27, vcc
    v_cndmask_b32 v28, 0, v28, vcc
    v_cndmask_b32 v29, 0, v29, vcc
    v_cndmask_b32 v30, 0, v30, vcc
    v_cndmask_b32 v31, 0, v31, vcc
    v_cndmask_b32 v32, 0, v32, vcc
    v_cndmask_b32 v33, 0, v33, vcc
    v_cndmask_b32 v34, 0, v34, vcc
    v_cndmask_b32 v35, 0, v35, vcc
    v_cndmask_b32 v36, 0, v36, vcc
    v_cndmask_b32 v37, 0, v37, vcc
    v_cndmask_b32 v38, 0, v38, vcc
    v_cndmask_b32 v39, 0, v39, vcc
    v_lshrrev_b32 v8, 2, v3
    v_lshl_add_u32 v8, v4, 2, v8
    v_lshlrev_b32 v8, 8, v8
    v_and_b32 v9, 3, v3
    v_lshl_add_u32 v8, v9, 3, v8
    v_add_u32 v8, s29, v8
    v_mov_b32 v136, 0
    v_mov_b32 v137, 0
    v_mov_b32 v138, 0
    v_mov_b32 v139, 0
    v_mov_b32 v140, 0
    v_mov_b32 v141, 0
    v_mov_b32 v142, 0
    v_mov_b32 v143, 0
    v_mov_b32 v144, 0
    v_mov_b32 v145, 0
    v_mov_b32 v146, 0
    v_mov_b32 v147, 0
    v_mov_b32 v148, 0
    v_mov_b32 v149, 0
    v_mov_b32 v150, 0
    v_mov_b32 v151, 0
    v_mov_b32 v152, 0
    v_mov_b32 v153, 0
    v_mov_b32 v154, 0
    v_mov_b32 v155, 0
    v_mov_b32 v156, 0
    v_mov_b32 v157, 0
    v_mov_b32 v158, 0
    v_mov_b32 v159, 0
    v_mov_b32 v160, 0
    v_mov_b32 v161, 0
    v_mov_b32 v162, 0
    v_mov_b32 v163, 0
    v_mov_b32 v164, 0
    v_mov_b32 v165, 0
    v_mov_b32 v166, 0
    v_mov_b32 v167, 0
    v_mov_b32 v170, 0xff800000
    v_mov_b32 v171, 0
    s_waitcnt vmcnt(24)
    v_mfma_f32_16x16x32_bf16 v[10:13], v[40:43], v[24:27], 0
    v_mfma_f32_16x16x32_bf16 v[10:13], v[44:47], v[28:31], v[10:13]
    v_mfma_f32_16x16x32_bf16 v[10:13], v[48:51], v[32:35], v[10:13]
    v_mfma_f32_16x16x32_bf16 v[10:13], v[52:55], v[36:39], v[10:13]
    v_mfma_f32_16x16x32_bf16 v[14:17], v[56:59], v[24:27], 0
    v_mfma_f32_16x16x32_bf16 v[14:17], v[60:63], v[28:31], v[14:17]
    v_mfma_f32_16x16x32_bf16 v[14:17], v[64:67], v[32:35], v[14:17]
    v_mfma_f32_16x16x32_bf16 v[14:17], v[68:71], v[36:39], v[14:17]
    s_nop 7
    s_nop 1
    v_cvt_pk_bf16_f32 v18, v10, v11
    v_lshlrev_b32 v10, 16, v18
    v_and_b32 v11, 0xffff0000, v18
    v_mul_f32 v10, 1035273459, v10
    v_mul_f32 v11, 1035273459, v11
    v_cvt_pk_bf16_f32 v18, v10, v11
    v_lshlrev_b32 v10, 16, v18
    v_and_b32 v11, 0xffff0000, v18
    v_cvt_pk_bf16_f32 v18, v12, v13
    v_lshlrev_b32 v12, 16, v18
    v_and_b32 v13, 0xffff0000, v18
    v_mul_f32 v12, 1035273459, v12
    v_mul_f32 v13, 1035273459, v13
    v_cvt_pk_bf16_f32 v18, v12, v13
    v_lshlrev_b32 v12, 16, v18
    v_and_b32 v13, 0xffff0000, v18
    v_cvt_pk_bf16_f32 v18, v14, v15
    v_lshlrev_b32 v14, 16, v18
    v_and_b32 v15, 0xffff0000, v18
    v_mul_f32 v14, 1035273459, v14
    v_mul_f32 v15, 1035273459, v15
    v_cvt_pk_bf16_f32 v18, v14, v15
    v_lshlrev_b32 v14, 16, v18
    v_and_b32 v15, 0xffff0000, v18
    v_cvt_pk_bf16_f32 v18, v16, v17
    v_lshlrev_b32 v16, 16, v18
    v_and_b32 v17, 0xffff0000, v18
    v_mul_f32 v16, 1035273459, v16
    v_mul_f32 v17, 1035273459, v17
    v_cvt_pk_bf16_f32 v18, v16, v17
    v_lshlrev_b32 v16, 16, v18
    v_and_b32 v17, 0xffff0000, v18
    v_max3_f32 v18, v10, v11, v12
    v_max3_f32 v19, v13, v14, v15
    v_max3_f32 v18, v18, v16, v17
    v_max_f32 v18, v18, v19
    v_mov_b32 v19, v18
    s_nop 1
    v_permlane32_swap_b32 v18, v19
    v_max_f32 v18, v18, v19
    v_mov_b32 v19, v18
    s_nop 1
    v_permlane16_swap_b32 v18, v19
    v_max_f32 v18, v18, v19
    v_max_f32 v19, v170, v18
    v_sub_f32 v20, v170, v19
    v_mul_f32 v20, 1069066811, v20
    v_exp_f32 v20, v20
    v_mov_b32 v170, v19
    v_sub_f32 v10, v10, v19
    v_mul_f32 v10, 1069066811, v10
    v_exp_f32 v10, v10
    v_sub_f32 v11, v11, v19
    v_mul_f32 v11, 1069066811, v11
    v_exp_f32 v11, v11
    v_sub_f32 v12, v12, v19
    v_mul_f32 v12, 1069066811, v12
    v_exp_f32 v12, v12
    v_sub_f32 v13, v13, v19
    v_mul_f32 v13, 1069066811, v13
    v_exp_f32 v13, v13
    v_sub_f32 v14, v14, v19
    v_mul_f32 v14, 1069066811, v14
    v_exp_f32 v14, v14
    v_sub_f32 v15, v15, v19
    v_mul_f32 v15, 1069066811, v15
    v_exp_f32 v15, v15
    v_sub_f32 v16, v16, v19
    v_mul_f32 v16, 1069066811, v16
    v_exp_f32 v16, v16
    v_sub_f32 v17, v17, v19
    v_mul_f32 v17, 1069066811, v17
    v_exp_f32 v17, v17
    v_mul_f32 v171, v171, v20
    v_add_f32 v171, v171, v10
    v_add_f32 v171, v171, v11
    v_add_f32 v171, v171, v12
    v_add_f32 v171, v171, v13
    v_add_f32 v171, v171, v14
    v_add_f32 v171, v171, v15
    v_add_f32 v171, v171, v16
    v_add_f32 v171, v171, v17
    v_mul_f32 v136, v136, v20
    v_mul_f32 v137, v137, v20
    v_mul_f32 v138, v138, v20
    v_mul_f32 v139, v139, v20
    v_mul_f32 v140, v140, v20
    v_mul_f32 v141, v141, v20
    v_mul_f32 v142, v142, v20
    v_mul_f32 v143, v143, v20
    v_mul_f32 v144, v144, v20
    v_mul_f32 v145, v145, v20
    v_mul_f32 v146, v146, v20
    v_mul_f32 v147, v147, v20
    v_mul_f32 v148, v148, v20
    v_mul_f32 v149, v149, v20
    v_mul_f32 v150, v150, v20
    v_mul_f32 v151, v151, v20
    v_mul_f32 v152, v152, v20
    v_mul_f32 v153, v153, v20
    v_mul_f32 v154, v154, v20
    v_mul_f32 v155, v155, v20
    v_mul_f32 v156, v156, v20
    v_mul_f32 v157, v157, v20
    v_mul_f32 v158, v158, v20
    v_mul_f32 v159, v159, v20
    v_mul_f32 v160, v160, v20
    v_mul_f32 v161, v161, v20
    v_mul_f32 v162, v162, v20
    v_mul_f32 v163, v163, v20
    v_mul_f32 v164, v164, v20
    v_mul_f32 v165, v165, v20
    v_mul_f32 v166, v166, v20
    v_mul_f32 v167, v167, v20
    v_cvt_pk_bf16_f32 v20, v10, v11
    v_cvt_pk_bf16_f32 v21, v12, v13
    v_cvt_pk_bf16_f32 v22, v14, v15
    v_cvt_pk_bf16_f32 v23, v16, v17
    s_waitcnt vmcnt(16)
    ds_read_b64_tr_b16 v[172:173], v8 offset:0
    ds_read_b64_tr_b16 v[174:175], v8 offset:4096
    s_waitcnt lgkmcnt(0)
    v_mfma_f32_16x16x32_bf16 v[136:139], v[172:175], v[20:23], v[136:139]
    ds_read_b64_tr_b16 v[176:177], v8 offset:32
    ds_read_b64_tr_b16 v[178:179], v8 offset:4128
    s_waitcnt lgkmcnt(0)
    v_mfma_f32_16x16x32_bf16 v[140:143], v[176:179], v[20:23], v[140:143]
    ds_read_b64_tr_b16 v[172:173], v8 offset:64
    ds_read_b64_tr_b16 v[174:175], v8 offset:4160
    s_waitcnt lgkmcnt(0)
    v_mfma_f32_16x16x32_bf16 v[144:147], v[172:175], v[20:23], v[144:147]
    ds_read_b64_tr_b16 v[176:177], v8 offset:96
    ds_read_b64_tr_b16 v[178:179], v8 offset:4192
    s_waitcnt lgkmcnt(0)
    v_mfma_f32_16x16x32_bf16 v[148:151], v[176:179], v[20:23], v[148:151]
    ds_read_b64_tr_b16 v[172:173], v8 offset:128
    ds_read_b64_tr_b16 v[174:175], v8 offset:4224
    s_waitcnt lgkmcnt(0)
    v_mfma_f32_16x16x32_bf16 v[152:155], v[172:175], v[20:23], v[152:155]
    ds_read_b64_tr_b16 v[176:177], v8 offset:160
    ds_read_b64_tr_b16 v[178:179], v8 offset:4256
    s_waitcnt lgkmcnt(0)
    v_mfma_f32_16x16x32_bf16 v[156:159], v[176:179], v[20:23], v[156:159]
    ds_read_b64_tr_b16 v[172:173], v8 offset:192
    ds_read_b64_tr_b16 v[174:175], v8 offset:4288
    s_waitcnt lgkmcnt(0)
    v_mfma_f32_16x16x32_bf16 v[160:163], v[172:175], v[20:23], v[160:163]
    ds_read_b64_tr_b16 v[176:177], v8 offset:224
    ds_read_b64_tr_b16 v[178:179], v8 offset:4320
    s_waitcnt lgkmcnt(0)
    v_mfma_f32_16x16x32_bf16 v[164:167], v[176:179], v[20:23], v[164:167]
    s_add_u32 s30, s23, 16384
    s_add_u32 s31, s30, 4096
    buffer_load_dwordx4 v[40:43], v5, s[4:7], s30 offen offset:0 nt
    buffer_load_dwordx4 v[44:47], v5, s[4:7], s30 offen offset:64 nt
    buffer_load_dwordx4 v[48:51], v5, s[4:7], s30 offen offset:128 nt
    buffer_load_dwordx4 v[52:55], v5, s[4:7], s30 offen offset:192 nt
    buffer_load_dwordx4 v[56:59], v5, s[4:7], s31 offen offset:0 nt
    buffer_load_dwordx4 v[60:63], v5, s[4:7], s31 offen offset:64 nt
    buffer_load_dwordx4 v[64:67], v5, s[4:7], s31 offen offset:128 nt
    buffer_load_dwordx4 v[68:71], v5, s[4:7], s31 offen offset:192 nt
    s_add_u32 s32, s29, 0
    s_mov_b32 m0, s32
    s_nop 0
    buffer_load_dwordx4 v6, s[24:27], s30 offen offset:0 lds
    buffer_load_dwordx4 v6, s[24:27], s30 offen offset:1024 lds
    buffer_load_dwordx4 v6, s[24:27], s30 offen offset:2048 lds
    buffer_load_dwordx4 v6, s[24:27], s30 offen offset:3072 lds
    s_add_u32 s32, s29, 4096
    s_mov_b32 m0, s32
    s_nop 0
    buffer_load_dwordx4 v6, s[24:27], s31 offen offset:0 lds
    buffer_load_dwordx4 v6, s[24:27], s31 offen offset:1024 lds
    buffer_load_dwordx4 v6, s[24:27], s31 offen offset:2048 lds
    buffer_load_dwordx4 v6, s[24:27], s31 offen offset:3072 lds
    s_nop 7
    s_waitcnt vmcnt(24)
    v_mfma_f32_16x16x32_bf16 v[10:13], v[72:75], v[24:27], 0
    v_mfma_f32_16x16x32_bf16 v[10:13], v[76:79], v[28:31], v[10:13]
    v_mfma_f32_16x16x32_bf16 v[10:13], v[80:83], v[32:35], v[10:13]
    v_mfma_f32_16x16x32_bf16 v[10:13], v[84:87], v[36:39], v[10:13]
    v_mfma_f32_16x16x32_bf16 v[14:17], v[88:91], v[24:27], 0
    v_mfma_f32_16x16x32_bf16 v[14:17], v[92:95], v[28:31], v[14:17]
    v_mfma_f32_16x16x32_bf16 v[14:17], v[96:99], v[32:35], v[14:17]
    v_mfma_f32_16x16x32_bf16 v[14:17], v[100:103], v[36:39], v[14:17]
    s_nop 7
    s_nop 1
    v_cvt_pk_bf16_f32 v18, v10, v11
    v_lshlrev_b32 v10, 16, v18
    v_and_b32 v11, 0xffff0000, v18
    v_mul_f32 v10, 1035273459, v10
    v_mul_f32 v11, 1035273459, v11
    v_cvt_pk_bf16_f32 v18, v10, v11
    v_lshlrev_b32 v10, 16, v18
    v_and_b32 v11, 0xffff0000, v18
    v_cvt_pk_bf16_f32 v18, v12, v13
    v_lshlrev_b32 v12, 16, v18
    v_and_b32 v13, 0xffff0000, v18
    v_mul_f32 v12, 1035273459, v12
    v_mul_f32 v13, 1035273459, v13
    v_cvt_pk_bf16_f32 v18, v12, v13
    v_lshlrev_b32 v12, 16, v18
    v_and_b32 v13, 0xffff0000, v18
    v_cvt_pk_bf16_f32 v18, v14, v15
    v_lshlrev_b32 v14, 16, v18
    v_and_b32 v15, 0xffff0000, v18
    v_mul_f32 v14, 1035273459, v14
    v_mul_f32 v15, 1035273459, v15
    v_cvt_pk_bf16_f32 v18, v14, v15
    v_lshlrev_b32 v14, 16, v18
    v_and_b32 v15, 0xffff0000, v18
    v_cvt_pk_bf16_f32 v18, v16, v17
    v_lshlrev_b32 v16, 16, v18
    v_and_b32 v17, 0xffff0000, v18
    v_mul_f32 v16, 1035273459, v16
    v_mul_f32 v17, 1035273459, v17
    v_cvt_pk_bf16_f32 v18, v16, v17
    v_lshlrev_b32 v16, 16, v18
    v_and_b32 v17, 0xffff0000, v18
    v_max3_f32 v18, v10, v11, v12
    v_max3_f32 v19, v13, v14, v15
    v_max3_f32 v18, v18, v16, v17
    v_max_f32 v18, v18, v19
    v_mov_b32 v19, v18
    s_nop 1
    v_permlane32_swap_b32 v18, v19
    v_max_f32 v18, v18, v19
    v_mov_b32 v19, v18
    s_nop 1
    v_permlane16_swap_b32 v18, v19
    v_max_f32 v18, v18, v19
    v_max_f32 v19, v170, v18
    v_sub_f32 v20, v170, v19
    v_mul_f32 v20, 1069066811, v20
    v_exp_f32 v20, v20
    v_mov_b32 v170, v19
    v_sub_f32 v10, v10, v19
    v_mul_f32 v10, 1069066811, v10
    v_exp_f32 v10, v10
    v_sub_f32 v11, v11, v19
    v_mul_f32 v11, 1069066811, v11
    v_exp_f32 v11, v11
    v_sub_f32 v12, v12, v19
    v_mul_f32 v12, 1069066811, v12
    v_exp_f32 v12, v12
    v_sub_f32 v13, v13, v19
    v_mul_f32 v13, 1069066811, v13
    v_exp_f32 v13, v13
    v_sub_f32 v14, v14, v19
    v_mul_f32 v14, 1069066811, v14
    v_exp_f32 v14, v14
    v_sub_f32 v15, v15, v19
    v_mul_f32 v15, 1069066811, v15
    v_exp_f32 v15, v15
    v_sub_f32 v16, v16, v19
    v_mul_f32 v16, 1069066811, v16
    v_exp_f32 v16, v16
    v_sub_f32 v17, v17, v19
    v_mul_f32 v17, 1069066811, v17
    v_exp_f32 v17, v17
    v_mul_f32 v171, v171, v20
    v_add_f32 v171, v171, v10
    v_add_f32 v171, v171, v11
    v_add_f32 v171, v171, v12
    v_add_f32 v171, v171, v13
    v_add_f32 v171, v171, v14
    v_add_f32 v171, v171, v15
    v_add_f32 v171, v171, v16
    v_add_f32 v171, v171, v17
    v_mul_f32 v136, v136, v20
    v_mul_f32 v137, v137, v20
    v_mul_f32 v138, v138, v20
    v_mul_f32 v139, v139, v20
    v_mul_f32 v140, v140, v20
    v_mul_f32 v141, v141, v20
    v_mul_f32 v142, v142, v20
    v_mul_f32 v143, v143, v20
    v_mul_f32 v144, v144, v20
    v_mul_f32 v145, v145, v20
    v_mul_f32 v146, v146, v20
    v_mul_f32 v147, v147, v20
    v_mul_f32 v148, v148, v20
    v_mul_f32 v149, v149, v20
    v_mul_f32 v150, v150, v20
    v_mul_f32 v151, v151, v20
    v_mul_f32 v152, v152, v20
    v_mul_f32 v153, v153, v20
    v_mul_f32 v154, v154, v20
    v_mul_f32 v155, v155, v20
    v_mul_f32 v156, v156, v20
    v_mul_f32 v157, v157, v20
    v_mul_f32 v158, v158, v20
    v_mul_f32 v159, v159, v20
    v_mul_f32 v160, v160, v20
    v_mul_f32 v161, v161, v20
    v_mul_f32 v162, v162, v20
    v_mul_f32 v163, v163, v20
    v_mul_f32 v164, v164, v20
    v_mul_f32 v165, v165, v20
    v_mul_f32 v166, v166, v20
    v_mul_f32 v167, v167, v20
    v_cvt_pk_bf16_f32 v20, v10, v11
    v_cvt_pk_bf16_f32 v21, v12, v13
    v_cvt_pk_bf16_f32 v22, v14, v15
    v_cvt_pk_bf16_f32 v23, v16, v17
    s_waitcnt vmcnt(16)
    ds_read_b64_tr_b16 v[172:173], v8 offset:8192
    ds_read_b64_tr_b16 v[174:175], v8 offset:12288
    s_waitcnt lgkmcnt(0)
    v_mfma_f32_16x16x32_bf16 v[136:139], v[172:175], v[20:23], v[136:139]
    ds_read_b64_tr_b16 v[176:177], v8 offset:8224
    ds_read_b64_tr_b16 v[178:179], v8 offset:12320
    s_waitcnt lgkmcnt(0)
    v_mfma_f32_16x16x32_bf16 v[140:143], v[176:179], v[20:23], v[140:143]
    ds_read_b64_tr_b16 v[172:173], v8 offset:8256
    ds_read_b64_tr_b16 v[174:175], v8 offset:12352
    s_waitcnt lgkmcnt(0)
    v_mfma_f32_16x16x32_bf16 v[144:147], v[172:175], v[20:23], v[144:147]
    ds_read_b64_tr_b16 v[176:177], v8 offset:8288
    ds_read_b64_tr_b16 v[178:179], v8 offset:12384
    s_waitcnt lgkmcnt(0)
    v_mfma_f32_16x16x32_bf16 v[148:151], v[176:179], v[20:23], v[148:151]
    ds_read_b64_tr_b16 v[172:173], v8 offset:8320
    ds_read_b64_tr_b16 v[174:175], v8 offset:12416
    s_waitcnt lgkmcnt(0)
    v_mfma_f32_16x16x32_bf16 v[152:155], v[172:175], v[20:23], v[152:155]
    ds_read_b64_tr_b16 v[176:177], v8 offset:8352
    ds_read_b64_tr_b16 v[178:179], v8 offset:12448
    s_waitcnt lgkmcnt(0)
    v_mfma_f32_16x16x32_bf16 v[156:159], v[176:179], v[20:23], v[156:159]
    ds_read_b64_tr_b16 v[172:173], v8 offset:8384
    ds_read_b64_tr_b16 v[174:175], v8 offset:12480
    s_waitcnt lgkmcnt(0)
    v_mfma_f32_16x16x32_bf16 v[160:163], v[172:175], v[20:23], v[160:163]
    ds_read_b64_tr_b16 v[176:177], v8 offset:8416
    ds_read_b64_tr_b16 v[178:179], v8 offset:12512
    s_waitcnt lgkmcnt(0)
    v_mfma_f32_16x16x32_bf16 v[164:167], v[176:179], v[20:23], v[164:167]
    s_add_u32 s30, s23, 24576
    s_add_u32 s31, s30, 4096
    buffer_load_dwordx4 v[72:75], v5, s[4:7], s30 offen offset:0 nt
    buffer_load_dwordx4 v[76:79], v5, s[4:7], s30 offen offset:64 nt
    buffer_load_dwordx4 v[80:83], v5, s[4:7], s30 offen offset:128 nt
    buffer_load_dwordx4 v[84:87], v5, s[4:7], s30 offen offset:192 nt
    buffer_load_dwordx4 v[88:91], v5, s[4:7], s31 offen offset:0 nt
    buffer_load_dwordx4 v[92:95], v5, s[4:7], s31 offen offset:64 nt
    buffer_load_dwordx4 v[96:99], v5, s[4:7], s31 offen offset:128 nt
    buffer_load_dwordx4 v[100:103], v5, s[4:7], s31 offen offset:192 nt
    s_add_u32 s32, s29, 8192
    s_mov_b32 m0, s32
    s_nop 0
    buffer_load_dwordx4 v6, s[24:27], s30 offen offset:0 lds
    buffer_load_dwordx4 v6, s[24:27], s30 offen offset:1024 lds
    buffer_load_dwordx4 v6, s[24:27], s30 offen offset:2048 lds
    buffer_load_dwordx4 v6, s[24:27], s30 offen offset:3072 lds
    s_add_u32 s32, s29, 12288
    s_mov_b32 m0, s32
    s_nop 0
    buffer_load_dwordx4 v6, s[24:27], s31 offen offset:0 lds
    buffer_load_dwordx4 v6, s[24:27], s31 offen offset:1024 lds
    buffer_load_dwordx4 v6, s[24:27], s31 offen offset:2048 lds
    buffer_load_dwordx4 v6, s[24:27], s31 offen offset:3072 lds
    s_nop 7
    s_waitcnt vmcnt(24)
    v_mfma_f32_16x16x32_bf16 v[10:13], v[40:43], v[24:27], 0
    v_mfma_f32_16x16x32_bf16 v[10:13], v[44:47], v[28:31], v[10:13]
    v_mfma_f32_16x16x32_bf16 v[10:13], v[48:51], v[32:35], v[10:13]
    v_mfma_f32_16x16x32_bf16 v[10:13], v[52:55], v[36:39], v[10:13]
    v_mfma_f32_16x16x32_bf16 v[14:17], v[56:59], v[24:27], 0
    v_mfma_f32_16x16x32_bf16 v[14:17], v[60:63], v[28:31], v[14:17]
    v_mfma_f32_16x16x32_bf16 v[14:17], v[64:67], v[32:35], v[14:17]
    v_mfma_f32_16x16x32_bf16 v[14:17], v[68:71], v[36:39], v[14:17]
    s_nop 7
    s_nop 1
    v_cvt_pk_bf16_f32 v18, v10, v11
    v_lshlrev_b32 v10, 16, v18
    v_and_b32 v11, 0xffff0000, v18
    v_mul_f32 v10, 1035273459, v10
    v_mul_f32 v11, 1035273459, v11
    v_cvt_pk_bf16_f32 v18, v10, v11
    v_lshlrev_b32 v10, 16, v18
    v_and_b32 v11, 0xffff0000, v18
    v_cvt_pk_bf16_f32 v18, v12, v13
    v_lshlrev_b32 v12, 16, v18
    v_and_b32 v13, 0xffff0000, v18
    v_mul_f32 v12, 1035273459, v12
    v_mul_f32 v13, 1035273459, v13
    v_cvt_pk_bf16_f32 v18, v12, v13
    v_lshlrev_b32 v12, 16, v18
    v_and_b32 v13, 0xffff0000, v18
    v_cvt_pk_bf16_f32 v18, v14, v15
    v_lshlrev_b32 v14, 16, v18
    v_and_b32 v15, 0xffff0000, v18
    v_mul_f32 v14, 1035273459, v14
    v_mul_f32 v15, 1035273459, v15
    v_cvt_pk_bf16_f32 v18, v14, v15
    v_lshlrev_b32 v14, 16, v18
    v_and_b32 v15, 0xffff0000, v18
    v_cvt_pk_bf16_f32 v18, v16, v17
    v_lshlrev_b32 v16, 16, v18
    v_and_b32 v17, 0xffff0000, v18
    v_mul_f32 v16, 1035273459, v16
    v_mul_f32 v17, 1035273459, v17
    v_cvt_pk_bf16_f32 v18, v16, v17
    v_lshlrev_b32 v16, 16, v18
    v_and_b32 v17, 0xffff0000, v18
    v_max3_f32 v18, v10, v11, v12
    v_max3_f32 v19, v13, v14, v15
    v_max3_f32 v18, v18, v16, v17
    v_max_f32 v18, v18, v19
    v_mov_b32 v19, v18
    s_nop 1
    v_permlane32_swap_b32 v18, v19
    v_max_f32 v18, v18, v19
    v_mov_b32 v19, v18
    s_nop 1
    v_permlane16_swap_b32 v18, v19
    v_max_f32 v18, v18, v19
    v_max_f32 v19, v170, v18
    v_sub_f32 v20, v170, v19
    v_mul_f32 v20, 1069066811, v20
    v_exp_f32 v20, v20
    v_mov_b32 v170, v19
    v_sub_f32 v10, v10, v19
    v_mul_f32 v10, 1069066811, v10
    v_exp_f32 v10, v10
    v_sub_f32 v11, v11, v19
    v_mul_f32 v11, 1069066811, v11
    v_exp_f32 v11, v11
    v_sub_f32 v12, v12, v19
    v_mul_f32 v12, 1069066811, v12
    v_exp_f32 v12, v12
    v_sub_f32 v13, v13, v19
    v_mul_f32 v13, 1069066811, v13
    v_exp_f32 v13, v13
    v_sub_f32 v14, v14, v19
    v_mul_f32 v14, 1069066811, v14
    v_exp_f32 v14, v14
    v_sub_f32 v15, v15, v19
    v_mul_f32 v15, 1069066811, v15
    v_exp_f32 v15, v15
    v_sub_f32 v16, v16, v19
    v_mul_f32 v16, 1069066811, v16
    v_exp_f32 v16, v16
    v_sub_f32 v17, v17, v19
    v_mul_f32 v17, 1069066811, v17
    v_exp_f32 v17, v17
    v_mul_f32 v171, v171, v20
    v_add_f32 v171, v171, v10
    v_add_f32 v171, v171, v11
    v_add_f32 v171, v171, v12
    v_add_f32 v171, v171, v13
    v_add_f32 v171, v171, v14
    v_add_f32 v171, v171, v15
    v_add_f32 v171, v171, v16
    v_add_f32 v171, v171, v17
    v_mul_f32 v136, v136, v20
    v_mul_f32 v137, v137, v20
    v_mul_f32 v138, v138, v20
    v_mul_f32 v139, v139, v20
    v_mul_f32 v140, v140, v20
    v_mul_f32 v141, v141, v20
    v_mul_f32 v142, v142, v20
    v_mul_f32 v143, v143, v20
    v_mul_f32 v144, v144, v20
    v_mul_f32 v145, v145, v20
    v_mul_f32 v146, v146, v20
    v_mul_f32 v147, v147, v20
    v_mul_f32 v148, v148, v20
    v_mul_f32 v149, v149, v20
    v_mul_f32 v150, v150, v20
    v_mul_f32 v151, v151, v20
    v_mul_f32 v152, v152, v20
    v_mul_f32 v153, v153, v20
    v_mul_f32 v154, v154, v20
    v_mul_f32 v155, v155, v20
    v_mul_f32 v156, v156, v20
    v_mul_f32 v157, v157, v20
    v_mul_f32 v158, v158, v20
    v_mul_f32 v159, v159, v20
    v_mul_f32 v160, v160, v20
    v_mul_f32 v161, v161, v20
    v_mul_f32 v162, v162, v20
    v_mul_f32 v163, v163, v20
    v_mul_f32 v164, v164, v20
    v_mul_f32 v165, v165, v20
    v_mul_f32 v166, v166, v20
    v_mul_f32 v167, v167, v20
    v_cvt_pk_bf16_f32 v20, v10, v11
    v_cvt_pk_bf16_f32 v21, v12, v13
    v_cvt_pk_bf16_f32 v22, v14, v15
    v_cvt_pk_bf16_f32 v23, v16, v17
    s_waitcnt vmcnt(16)
    ds_read_b64_tr_b16 v[172:173], v8 offset:0
    ds_read_b64_tr_b16 v[174:175], v8 offset:4096
    s_waitcnt lgkmcnt(0)
    v_mfma_f32_16x16x32_bf16 v[136:139], v[172:175], v[20:23], v[136:139]
    ds_read_b64_tr_b16 v[176:177], v8 offset:32
    ds_read_b64_tr_b16 v[178:179], v8 offset:4128
    s_waitcnt lgkmcnt(0)
    v_mfma_f32_16x16x32_bf16 v[140:143], v[176:179], v[20:23], v[140:143]
    ds_read_b64_tr_b16 v[172:173], v8 offset:64
    ds_read_b64_tr_b16 v[174:175], v8 offset:4160
    s_waitcnt lgkmcnt(0)
    v_mfma_f32_16x16x32_bf16 v[144:147], v[172:175], v[20:23], v[144:147]
    ds_read_b64_tr_b16 v[176:177], v8 offset:96
    ds_read_b64_tr_b16 v[178:179], v8 offset:4192
    s_waitcnt lgkmcnt(0)
    v_mfma_f32_16x16x32_bf16 v[148:151], v[176:179], v[20:23], v[148:151]
    ds_read_b64_tr_b16 v[172:173], v8 offset:128
    ds_read_b64_tr_b16 v[174:175], v8 offset:4224
    s_waitcnt lgkmcnt(0)
    v_mfma_f32_16x16x32_bf16 v[152:155], v[172:175], v[20:23], v[152:155]
    ds_read_b64_tr_b16 v[176:177], v8 offset:160
    ds_read_b64_tr_b16 v[178:179], v8 offset:4256
    s_waitcnt lgkmcnt(0)
    v_mfma_f32_16x16x32_bf16 v[156:159], v[176:179], v[20:23], v[156:159]
    ds_read_b64_tr_b16 v[172:173], v8 offset:192
    ds_read_b64_tr_b16 v[174:175], v8 offset:4288
    s_waitcnt lgkmcnt(0)
    v_mfma_f32_16x16x32_bf16 v[160:163], v[172:175], v[20:23], v[160:163]
    ds_read_b64_tr_b16 v[176:177], v8 offset:224
    ds_read_b64_tr_b16 v[178:179], v8 offset:4320
    s_waitcnt lgkmcnt(0)
    v_mfma_f32_16x16x32_bf16 v[164:167], v[176:179], v[20:23], v[164:167]
    s_add_u32 s30, s23, 32768
    s_add_u32 s31, s30, 4096
    buffer_load_dwordx4 v[40:43], v5, s[4:7], s30 offen offset:0 nt
    buffer_load_dwordx4 v[44:47], v5, s[4:7], s30 offen offset:64 nt
    buffer_load_dwordx4 v[48:51], v5, s[4:7], s30 offen offset:128 nt
    buffer_load_dwordx4 v[52:55], v5, s[4:7], s30 offen offset:192 nt
    buffer_load_dwordx4 v[56:59], v5, s[4:7], s31 offen offset:0 nt
    buffer_load_dwordx4 v[60:63], v5, s[4:7], s31 offen offset:64 nt
    buffer_load_dwordx4 v[64:67], v5, s[4:7], s31 offen offset:128 nt
    buffer_load_dwordx4 v[68:71], v5, s[4:7], s31 offen offset:192 nt
    s_add_u32 s32, s29, 0
    s_mov_b32 m0, s32
    s_nop 0
    buffer_load_dwordx4 v6, s[24:27], s30 offen offset:0 lds
    buffer_load_dwordx4 v6, s[24:27], s30 offen offset:1024 lds
    buffer_load_dwordx4 v6, s[24:27], s30 offen offset:2048 lds
    buffer_load_dwordx4 v6, s[24:27], s30 offen offset:3072 lds
    s_add_u32 s32, s29, 4096
    s_mov_b32 m0, s32
    s_nop 0
    buffer_load_dwordx4 v6, s[24:27], s31 offen offset:0 lds
    buffer_load_dwordx4 v6, s[24:27], s31 offen offset:1024 lds
    buffer_load_dwordx4 v6, s[24:27], s31 offen offset:2048 lds
    buffer_load_dwordx4 v6, s[24:27], s31 offen offset:3072 lds
    s_nop 7
    s_waitcnt vmcnt(24)
    v_mfma_f32_16x16x32_bf16 v[10:13], v[72:75], v[24:27], 0
    v_mfma_f32_16x16x32_bf16 v[10:13], v[76:79], v[28:31], v[10:13]
    v_mfma_f32_16x16x32_bf16 v[10:13], v[80:83], v[32:35], v[10:13]
    v_mfma_f32_16x16x32_bf16 v[10:13], v[84:87], v[36:39], v[10:13]
    v_mfma_f32_16x16x32_bf16 v[14:17], v[88:91], v[24:27], 0
    v_mfma_f32_16x16x32_bf16 v[14:17], v[92:95], v[28:31], v[14:17]
    v_mfma_f32_16x16x32_bf16 v[14:17], v[96:99], v[32:35], v[14:17]
    v_mfma_f32_16x16x32_bf16 v[14:17], v[100:103], v[36:39], v[14:17]
    s_nop 7
    s_nop 1
    v_cvt_pk_bf16_f32 v18, v10, v11
    v_lshlrev_b32 v10, 16, v18
    v_and_b32 v11, 0xffff0000, v18
    v_mul_f32 v10, 1035273459, v10
    v_mul_f32 v11, 1035273459, v11
    v_cvt_pk_bf16_f32 v18, v10, v11
    v_lshlrev_b32 v10, 16, v18
    v_and_b32 v11, 0xffff0000, v18
    v_cvt_pk_bf16_f32 v18, v12, v13
    v_lshlrev_b32 v12, 16, v18
    v_and_b32 v13, 0xffff0000, v18
    v_mul_f32 v12, 1035273459, v12
    v_mul_f32 v13, 1035273459, v13
    v_cvt_pk_bf16_f32 v18, v12, v13
    v_lshlrev_b32 v12, 16, v18
    v_and_b32 v13, 0xffff0000, v18
    v_cvt_pk_bf16_f32 v18, v14, v15
    v_lshlrev_b32 v14, 16, v18
    v_and_b32 v15, 0xffff0000, v18
    v_mul_f32 v14, 1035273459, v14
    v_mul_f32 v15, 1035273459, v15
    v_cvt_pk_bf16_f32 v18, v14, v15
    v_lshlrev_b32 v14, 16, v18
    v_and_b32 v15, 0xffff0000, v18
    v_cvt_pk_bf16_f32 v18, v16, v17
    v_lshlrev_b32 v16, 16, v18
    v_and_b32 v17, 0xffff0000, v18
    v_mul_f32 v16, 1035273459, v16
    v_mul_f32 v17, 1035273459, v17
    v_cvt_pk_bf16_f32 v18, v16, v17
    v_lshlrev_b32 v16, 16, v18
    v_and_b32 v17, 0xffff0000, v18
    v_max3_f32 v18, v10, v11, v12
    v_max3_f32 v19, v13, v14, v15
    v_max3_f32 v18, v18, v16, v17
    v_max_f32 v18, v18, v19
    v_mov_b32 v19, v18
    s_nop 1
    v_permlane32_swap_b32 v18, v19
    v_max_f32 v18, v18, v19
    v_mov_b32 v19, v18
    s_nop 1
    v_permlane16_swap_b32 v18, v19
    v_max_f32 v18, v18, v19
    v_max_f32 v19, v170, v18
    v_sub_f32 v20, v170, v19
    v_mul_f32 v20, 1069066811, v20
    v_exp_f32 v20, v20
    v_mov_b32 v170, v19
    v_sub_f32 v10, v10, v19
    v_mul_f32 v10, 1069066811, v10
    v_exp_f32 v10, v10
    v_sub_f32 v11, v11, v19
    v_mul_f32 v11, 1069066811, v11
    v_exp_f32 v11, v11
    v_sub_f32 v12, v12, v19
    v_mul_f32 v12, 1069066811, v12
    v_exp_f32 v12, v12
    v_sub_f32 v13, v13, v19
    v_mul_f32 v13, 1069066811, v13
    v_exp_f32 v13, v13
    v_sub_f32 v14, v14, v19
    v_mul_f32 v14, 1069066811, v14
    v_exp_f32 v14, v14
    v_sub_f32 v15, v15, v19
    v_mul_f32 v15, 1069066811, v15
    v_exp_f32 v15, v15
    v_sub_f32 v16, v16, v19
    v_mul_f32 v16, 1069066811, v16
    v_exp_f32 v16, v16
    v_sub_f32 v17, v17, v19
    v_mul_f32 v17, 1069066811, v17
    v_exp_f32 v17, v17
    v_mul_f32 v171, v171, v20
    v_add_f32 v171, v171, v10
    v_add_f32 v171, v171, v11
    v_add_f32 v171, v171, v12
    v_add_f32 v171, v171, v13
    v_add_f32 v171, v171, v14
    v_add_f32 v171, v171, v15
    v_add_f32 v171, v171, v16
    v_add_f32 v171, v171, v17
    v_mul_f32 v136, v136, v20
    v_mul_f32 v137, v137, v20
    v_mul_f32 v138, v138, v20
    v_mul_f32 v139, v139, v20
    v_mul_f32 v140, v140, v20
    v_mul_f32 v141, v141, v20
    v_mul_f32 v142, v142, v20
    v_mul_f32 v143, v143, v20
    v_mul_f32 v144, v144, v20
    v_mul_f32 v145, v145, v20
    v_mul_f32 v146, v146, v20
    v_mul_f32 v147, v147, v20
    v_mul_f32 v148, v148, v20
    v_mul_f32 v149, v149, v20
    v_mul_f32 v150, v150, v20
    v_mul_f32 v151, v151, v20
    v_mul_f32 v152, v152, v20
    v_mul_f32 v153, v153, v20
    v_mul_f32 v154, v154, v20
    v_mul_f32 v155, v155, v20
    v_mul_f32 v156, v156, v20
    v_mul_f32 v157, v157, v20
    v_mul_f32 v158, v158, v20
    v_mul_f32 v159, v159, v20
    v_mul_f32 v160, v160, v20
    v_mul_f32 v161, v161, v20
    v_mul_f32 v162, v162, v20
    v_mul_f32 v163, v163, v20
    v_mul_f32 v164, v164, v20
    v_mul_f32 v165, v165, v20
    v_mul_f32 v166, v166, v20
    v_mul_f32 v167, v167, v20
    v_cvt_pk_bf16_f32 v20, v10, v11
    v_cvt_pk_bf16_f32 v21, v12, v13
    v_cvt_pk_bf16_f32 v22, v14, v15
    v_cvt_pk_bf16_f32 v23, v16, v17
    s_waitcnt vmcnt(16)
    ds_read_b64_tr_b16 v[172:173], v8 offset:8192
    ds_read_b64_tr_b16 v[174:175], v8 offset:12288
    s_waitcnt lgkmcnt(0)
    v_mfma_f32_16x16x32_bf16 v[136:139], v[172:175], v[20:23], v[136:139]
    ds_read_b64_tr_b16 v[176:177], v8 offset:8224
    ds_read_b64_tr_b16 v[178:179], v8 offset:12320
    s_waitcnt lgkmcnt(0)
    v_mfma_f32_16x16x32_bf16 v[140:143], v[176:179], v[20:23], v[140:143]
    ds_read_b64_tr_b16 v[172:173], v8 offset:8256
    ds_read_b64_tr_b16 v[174:175], v8 offset:12352
    s_waitcnt lgkmcnt(0)
    v_mfma_f32_16x16x32_bf16 v[144:147], v[172:175], v[20:23], v[144:147]
    ds_read_b64_tr_b16 v[176:177], v8 offset:8288
    ds_read_b64_tr_b16 v[178:179], v8 offset:12384
    s_waitcnt lgkmcnt(0)
    v_mfma_f32_16x16x32_bf16 v[148:151], v[176:179], v[20:23], v[148:151]
    ds_read_b64_tr_b16 v[172:173], v8 offset:8320
    ds_read_b64_tr_b16 v[174:175], v8 offset:12416
    s_waitcnt lgkmcnt(0)
    v_mfma_f32_16x16x32_bf16 v[152:155], v[172:175], v[20:23], v[152:155]
    ds_read_b64_tr_b16 v[176:177], v8 offset:8352
    ds_read_b64_tr_b16 v[178:179], v8 offset:12448
    s_waitcnt lgkmcnt(0)
    v_mfma_f32_16x16x32_bf16 v[156:159], v[176:179], v[20:23], v[156:159]
    ds_read_b64_tr_b16 v[172:173], v8 offset:8384
    ds_read_b64_tr_b16 v[174:175], v8 offset:12480
    s_waitcnt lgkmcnt(0)
    v_mfma_f32_16x16x32_bf16 v[160:163], v[172:175], v[20:23], v[160:163]
    ds_read_b64_tr_b16 v[176:177], v8 offset:8416
    ds_read_b64_tr_b16 v[178:179], v8 offset:12512
    s_waitcnt lgkmcnt(0)
    v_mfma_f32_16x16x32_bf16 v[164:167], v[176:179], v[20:23], v[164:167]
    s_add_u32 s30, s23, 40960
    s_add_u32 s31, s30, 4096
    buffer_load_dwordx4 v[72:75], v5, s[4:7], s30 offen offset:0 nt
    buffer_load_dwordx4 v[76:79], v5, s[4:7], s30 offen offset:64 nt
    buffer_load_dwordx4 v[80:83], v5, s[4:7], s30 offen offset:128 nt
    buffer_load_dwordx4 v[84:87], v5, s[4:7], s30 offen offset:192 nt
    buffer_load_dwordx4 v[88:91], v5, s[4:7], s31 offen offset:0 nt
    buffer_load_dwordx4 v[92:95], v5, s[4:7], s31 offen offset:64 nt
    buffer_load_dwordx4 v[96:99], v5, s[4:7], s31 offen offset:128 nt
    buffer_load_dwordx4 v[100:103], v5, s[4:7], s31 offen offset:192 nt
    s_add_u32 s32, s29, 8192
    s_mov_b32 m0, s32
    s_nop 0
    buffer_load_dwordx4 v6, s[24:27], s30 offen offset:0 lds
    buffer_load_dwordx4 v6, s[24:27], s30 offen offset:1024 lds
    buffer_load_dwordx4 v6, s[24:27], s30 offen offset:2048 lds
    buffer_load_dwordx4 v6, s[24:27], s30 offen offset:3072 lds
    s_add_u32 s32, s29, 12288
    s_mov_b32 m0, s32
    s_nop 0
    buffer_load_dwordx4 v6, s[24:27], s31 offen offset:0 lds
    buffer_load_dwordx4 v6, s[24:27], s31 offen offset:1024 lds
    buffer_load_dwordx4 v6, s[24:27], s31 offen offset:2048 lds
    buffer_load_dwordx4 v6, s[24:27], s31 offen offset:3072 lds
    s_nop 7
    s_waitcnt vmcnt(24)
    v_mfma_f32_16x16x32_bf16 v[10:13], v[40:43], v[24:27], 0
    v_mfma_f32_16x16x32_bf16 v[10:13], v[44:47], v[28:31], v[10:13]
    v_mfma_f32_16x16x32_bf16 v[10:13], v[48:51], v[32:35], v[10:13]
    v_mfma_f32_16x16x32_bf16 v[10:13], v[52:55], v[36:39], v[10:13]
    v_mfma_f32_16x16x32_bf16 v[14:17], v[56:59], v[24:27], 0
    v_mfma_f32_16x16x32_bf16 v[14:17], v[60:63], v[28:31], v[14:17]
    v_mfma_f32_16x16x32_bf16 v[14:17], v[64:67], v[32:35], v[14:17]
    v_mfma_f32_16x16x32_bf16 v[14:17], v[68:71], v[36:39], v[14:17]
    s_nop 7
    s_nop 1
    v_cvt_pk_bf16_f32 v18, v10, v11
    v_lshlrev_b32 v10, 16, v18
    v_and_b32 v11, 0xffff0000, v18
    v_mul_f32 v10, 1035273459, v10
    v_mul_f32 v11, 1035273459, v11
    v_cvt_pk_bf16_f32 v18, v10, v11
    v_lshlrev_b32 v10, 16, v18
    v_and_b32 v11, 0xffff0000, v18
    v_cvt_pk_bf16_f32 v18, v12, v13
    v_lshlrev_b32 v12, 16, v18
    v_and_b32 v13, 0xffff0000, v18
    v_mul_f32 v12, 1035273459, v12
    v_mul_f32 v13, 1035273459, v13
    v_cvt_pk_bf16_f32 v18, v12, v13
    v_lshlrev_b32 v12, 16, v18
    v_and_b32 v13, 0xffff0000, v18
    v_cvt_pk_bf16_f32 v18, v14, v15
    v_lshlrev_b32 v14, 16, v18
    v_and_b32 v15, 0xffff0000, v18
    v_mul_f32 v14, 1035273459, v14
    v_mul_f32 v15, 1035273459, v15
    v_cvt_pk_bf16_f32 v18, v14, v15
    v_lshlrev_b32 v14, 16, v18
    v_and_b32 v15, 0xffff0000, v18
    v_cvt_pk_bf16_f32 v18, v16, v17
    v_lshlrev_b32 v16, 16, v18
    v_and_b32 v17, 0xffff0000, v18
    v_mul_f32 v16, 1035273459, v16
    v_mul_f32 v17, 1035273459, v17
    v_cvt_pk_bf16_f32 v18, v16, v17
    v_lshlrev_b32 v16, 16, v18
    v_and_b32 v17, 0xffff0000, v18
    v_max3_f32 v18, v10, v11, v12
    v_max3_f32 v19, v13, v14, v15
    v_max3_f32 v18, v18, v16, v17
    v_max_f32 v18, v18, v19
    v_mov_b32 v19, v18
    s_nop 1
    v_permlane32_swap_b32 v18, v19
    v_max_f32 v18, v18, v19
    v_mov_b32 v19, v18
    s_nop 1
    v_permlane16_swap_b32 v18, v19
    v_max_f32 v18, v18, v19
    v_max_f32 v19, v170, v18
    v_sub_f32 v20, v170, v19
    v_mul_f32 v20, 1069066811, v20
    v_exp_f32 v20, v20
    v_mov_b32 v170, v19
    v_sub_f32 v10, v10, v19
    v_mul_f32 v10, 1069066811, v10
    v_exp_f32 v10, v10
    v_sub_f32 v11, v11, v19
    v_mul_f32 v11, 1069066811, v11
    v_exp_f32 v11, v11
    v_sub_f32 v12, v12, v19
    v_mul_f32 v12, 1069066811, v12
    v_exp_f32 v12, v12
    v_sub_f32 v13, v13, v19
    v_mul_f32 v13, 1069066811, v13
    v_exp_f32 v13, v13
    v_sub_f32 v14, v14, v19
    v_mul_f32 v14, 1069066811, v14
    v_exp_f32 v14, v14
    v_sub_f32 v15, v15, v19
    v_mul_f32 v15, 1069066811, v15
    v_exp_f32 v15, v15
    v_sub_f32 v16, v16, v19
    v_mul_f32 v16, 1069066811, v16
    v_exp_f32 v16, v16
    v_sub_f32 v17, v17, v19
    v_mul_f32 v17, 1069066811, v17
    v_exp_f32 v17, v17
    v_mul_f32 v171, v171, v20
    v_add_f32 v171, v171, v10
    v_add_f32 v171, v171, v11
    v_add_f32 v171, v171, v12
    v_add_f32 v171, v171, v13
    v_add_f32 v171, v171, v14
    v_add_f32 v171, v171, v15
    v_add_f32 v171, v171, v16
    v_add_f32 v171, v171, v17
    v_mul_f32 v136, v136, v20
    v_mul_f32 v137, v137, v20
    v_mul_f32 v138, v138, v20
    v_mul_f32 v139, v139, v20
    v_mul_f32 v140, v140, v20
    v_mul_f32 v141, v141, v20
    v_mul_f32 v142, v142, v20
    v_mul_f32 v143, v143, v20
    v_mul_f32 v144, v144, v20
    v_mul_f32 v145, v145, v20
    v_mul_f32 v146, v146, v20
    v_mul_f32 v147, v147, v20
    v_mul_f32 v148, v148, v20
    v_mul_f32 v149, v149, v20
    v_mul_f32 v150, v150, v20
    v_mul_f32 v151, v151, v20
    v_mul_f32 v152, v152, v20
    v_mul_f32 v153, v153, v20
    v_mul_f32 v154, v154, v20
    v_mul_f32 v155, v155, v20
    v_mul_f32 v156, v156, v20
    v_mul_f32 v157, v157, v20
    v_mul_f32 v158, v158, v20
    v_mul_f32 v159, v159, v20
    v_mul_f32 v160, v160, v20
    v_mul_f32 v161, v161, v20
    v_mul_f32 v162, v162, v20
    v_mul_f32 v163, v163, v20
    v_mul_f32 v164, v164, v20
    v_mul_f32 v165, v165, v20
    v_mul_f32 v166, v166, v20
    v_mul_f32 v167, v167, v20
    v_cvt_pk_bf16_f32 v20, v10, v11
    v_cvt_pk_bf16_f32 v21, v12, v13
    v_cvt_pk_bf16_f32 v22, v14, v15
    v_cvt_pk_bf16_f32 v23, v16, v17
    s_waitcnt vmcnt(16)
    ds_read_b64_tr_b16 v[172:173], v8 offset:0
    ds_read_b64_tr_b16 v[174:175], v8 offset:4096
    s_waitcnt lgkmcnt(0)
    v_mfma_f32_16x16x32_bf16 v[136:139], v[172:175], v[20:23], v[136:139]
    ds_read_b64_tr_b16 v[176:177], v8 offset:32
    ds_read_b64_tr_b16 v[178:179], v8 offset:4128
    s_waitcnt lgkmcnt(0)
    v_mfma_f32_16x16x32_bf16 v[140:143], v[176:179], v[20:23], v[140:143]
    ds_read_b64_tr_b16 v[172:173], v8 offset:64
    ds_read_b64_tr_b16 v[174:175], v8 offset:4160
    s_waitcnt lgkmcnt(0)
    v_mfma_f32_16x16x32_bf16 v[144:147], v[172:175], v[20:23], v[144:147]
    ds_read_b64_tr_b16 v[176:177], v8 offset:96
    ds_read_b64_tr_b16 v[178:179], v8 offset:4192
    s_waitcnt lgkmcnt(0)
    v_mfma_f32_16x16x32_bf16 v[148:151], v[176:179], v[20:23], v[148:151]
    ds_read_b64_tr_b16 v[172:173], v8 offset:128
    ds_read_b64_tr_b16 v[174:175], v8 offset:4224
    s_waitcnt lgkmcnt(0)
    v_mfma_f32_16x16x32_bf16 v[152:155], v[172:175], v[20:23], v[152:155]
    ds_read_b64_tr_b16 v[176:177], v8 offset:160
    ds_read_b64_tr_b16 v[178:179], v8 offset:4256
    s_waitcnt lgkmcnt(0)
    v_mfma_f32_16x16x32_bf16 v[156:159], v[176:179], v[20:23], v[156:159]
    ds_read_b64_tr_b16 v[172:173], v8 offset:192
    ds_read_b64_tr_b16 v[174:175], v8 offset:4288
    s_waitcnt lgkmcnt(0)
    v_mfma_f32_16x16x32_bf16 v[160:163], v[172:175], v[20:23], v[160:163]
    ds_read_b64_tr_b16 v[176:177], v8 offset:224
    ds_read_b64_tr_b16 v[178:179], v8 offset:4320
    s_waitcnt lgkmcnt(0)
    v_mfma_f32_16x16x32_bf16 v[164:167], v[176:179], v[20:23], v[164:167]
    s_add_u32 s30, s23, 49152
    s_add_u32 s31, s30, 4096
    buffer_load_dwordx4 v[40:43], v5, s[4:7], s30 offen offset:0 nt
    buffer_load_dwordx4 v[44:47], v5, s[4:7], s30 offen offset:64 nt
    buffer_load_dwordx4 v[48:51], v5, s[4:7], s30 offen offset:128 nt
    buffer_load_dwordx4 v[52:55], v5, s[4:7], s30 offen offset:192 nt
    buffer_load_dwordx4 v[56:59], v5, s[4:7], s31 offen offset:0 nt
    buffer_load_dwordx4 v[60:63], v5, s[4:7], s31 offen offset:64 nt
    buffer_load_dwordx4 v[64:67], v5, s[4:7], s31 offen offset:128 nt
    buffer_load_dwordx4 v[68:71], v5, s[4:7], s31 offen offset:192 nt
    s_add_u32 s32, s29, 0
    s_mov_b32 m0, s32
    s_nop 0
    buffer_load_dwordx4 v6, s[24:27], s30 offen offset:0 lds
    buffer_load_dwordx4 v6, s[24:27], s30 offen offset:1024 lds
    buffer_load_dwordx4 v6, s[24:27], s30 offen offset:2048 lds
    buffer_load_dwordx4 v6, s[24:27], s30 offen offset:3072 lds
    s_add_u32 s32, s29, 4096
    s_mov_b32 m0, s32
    s_nop 0
    buffer_load_dwordx4 v6, s[24:27], s31 offen offset:0 lds
    buffer_load_dwordx4 v6, s[24:27], s31 offen offset:1024 lds
    buffer_load_dwordx4 v6, s[24:27], s31 offen offset:2048 lds
    buffer_load_dwordx4 v6, s[24:27], s31 offen offset:3072 lds
    s_nop 7
    s_waitcnt vmcnt(24)
    v_mfma_f32_16x16x32_bf16 v[10:13], v[72:75], v[24:27], 0
    v_mfma_f32_16x16x32_bf16 v[10:13], v[76:79], v[28:31], v[10:13]
    v_mfma_f32_16x16x32_bf16 v[10:13], v[80:83], v[32:35], v[10:13]
    v_mfma_f32_16x16x32_bf16 v[10:13], v[84:87], v[36:39], v[10:13]
    v_mfma_f32_16x16x32_bf16 v[14:17], v[88:91], v[24:27], 0
    v_mfma_f32_16x16x32_bf16 v[14:17], v[92:95], v[28:31], v[14:17]
    v_mfma_f32_16x16x32_bf16 v[14:17], v[96:99], v[32:35], v[14:17]
    v_mfma_f32_16x16x32_bf16 v[14:17], v[100:103], v[36:39], v[14:17]
    s_nop 7
    s_nop 1
    v_cvt_pk_bf16_f32 v18, v10, v11
    v_lshlrev_b32 v10, 16, v18
    v_and_b32 v11, 0xffff0000, v18
    v_mul_f32 v10, 1035273459, v10
    v_mul_f32 v11, 1035273459, v11
    v_cvt_pk_bf16_f32 v18, v10, v11
    v_lshlrev_b32 v10, 16, v18
    v_and_b32 v11, 0xffff0000, v18
    v_cvt_pk_bf16_f32 v18, v12, v13
    v_lshlrev_b32 v12, 16, v18
    v_and_b32 v13, 0xffff0000, v18
    v_mul_f32 v12, 1035273459, v12
    v_mul_f32 v13, 1035273459, v13
    v_cvt_pk_bf16_f32 v18, v12, v13
    v_lshlrev_b32 v12, 16, v18
    v_and_b32 v13, 0xffff0000, v18
    v_cvt_pk_bf16_f32 v18, v14, v15
    v_lshlrev_b32 v14, 16, v18
    v_and_b32 v15, 0xffff0000, v18
    v_mul_f32 v14, 1035273459, v14
    v_mul_f32 v15, 1035273459, v15
    v_cvt_pk_bf16_f32 v18, v14, v15
    v_lshlrev_b32 v14, 16, v18
    v_and_b32 v15, 0xffff0000, v18
    v_cvt_pk_bf16_f32 v18, v16, v17
    v_lshlrev_b32 v16, 16, v18
    v_and_b32 v17, 0xffff0000, v18
    v_mul_f32 v16, 1035273459, v16
    v_mul_f32 v17, 1035273459, v17
    v_cvt_pk_bf16_f32 v18, v16, v17
    v_lshlrev_b32 v16, 16, v18
    v_and_b32 v17, 0xffff0000, v18
    v_max3_f32 v18, v10, v11, v12
    v_max3_f32 v19, v13, v14, v15
    v_max3_f32 v18, v18, v16, v17
    v_max_f32 v18, v18, v19
    v_mov_b32 v19, v18
    s_nop 1
    v_permlane32_swap_b32 v18, v19
    v_max_f32 v18, v18, v19
    v_mov_b32 v19, v18
    s_nop 1
    v_permlane16_swap_b32 v18, v19
    v_max_f32 v18, v18, v19
    v_max_f32 v19, v170, v18
    v_sub_f32 v20, v170, v19
    v_mul_f32 v20, 1069066811, v20
    v_exp_f32 v20, v20
    v_mov_b32 v170, v19
    v_sub_f32 v10, v10, v19
    v_mul_f32 v10, 1069066811, v10
    v_exp_f32 v10, v10
    v_sub_f32 v11, v11, v19
    v_mul_f32 v11, 1069066811, v11
    v_exp_f32 v11, v11
    v_sub_f32 v12, v12, v19
    v_mul_f32 v12, 1069066811, v12
    v_exp_f32 v12, v12
    v_sub_f32 v13, v13, v19
    v_mul_f32 v13, 1069066811, v13
    v_exp_f32 v13, v13
    v_sub_f32 v14, v14, v19
    v_mul_f32 v14, 1069066811, v14
    v_exp_f32 v14, v14
    v_sub_f32 v15, v15, v19
    v_mul_f32 v15, 1069066811, v15
    v_exp_f32 v15, v15
    v_sub_f32 v16, v16, v19
    v_mul_f32 v16, 1069066811, v16
    v_exp_f32 v16, v16
    v_sub_f32 v17, v17, v19
    v_mul_f32 v17, 1069066811, v17
    v_exp_f32 v17, v17
    v_mul_f32 v171, v171, v20
    v_add_f32 v171, v171, v10
    v_add_f32 v171, v171, v11
    v_add_f32 v171, v171, v12
    v_add_f32 v171, v171, v13
    v_add_f32 v171, v171, v14
    v_add_f32 v171, v171, v15
    v_add_f32 v171, v171, v16
    v_add_f32 v171, v171, v17
    v_mul_f32 v136, v136, v20
    v_mul_f32 v137, v137, v20
    v_mul_f32 v138, v138, v20
    v_mul_f32 v139, v139, v20
    v_mul_f32 v140, v140, v20
    v_mul_f32 v141, v141, v20
    v_mul_f32 v142, v142, v20
    v_mul_f32 v143, v143, v20
    v_mul_f32 v144, v144, v20
    v_mul_f32 v145, v145, v20
    v_mul_f32 v146, v146, v20
    v_mul_f32 v147, v147, v20
    v_mul_f32 v148, v148, v20
    v_mul_f32 v149, v149, v20
    v_mul_f32 v150, v150, v20
    v_mul_f32 v151, v151, v20
    v_mul_f32 v152, v152, v20
    v_mul_f32 v153, v153, v20
    v_mul_f32 v154, v154, v20
    v_mul_f32 v155, v155, v20
    v_mul_f32 v156, v156, v20
    v_mul_f32 v157, v157, v20
    v_mul_f32 v158, v158, v20
    v_mul_f32 v159, v159, v20
    v_mul_f32 v160, v160, v20
    v_mul_f32 v161, v161, v20
    v_mul_f32 v162, v162, v20
    v_mul_f32 v163, v163, v20
    v_mul_f32 v164, v164, v20
    v_mul_f32 v165, v165, v20
    v_mul_f32 v166, v166, v20
    v_mul_f32 v167, v167, v20
    v_cvt_pk_bf16_f32 v20, v10, v11
    v_cvt_pk_bf16_f32 v21, v12, v13
    v_cvt_pk_bf16_f32 v22, v14, v15
    v_cvt_pk_bf16_f32 v23, v16, v17
    s_waitcnt vmcnt(16)
    ds_read_b64_tr_b16 v[172:173], v8 offset:8192
    ds_read_b64_tr_b16 v[174:175], v8 offset:12288
    s_waitcnt lgkmcnt(0)
    v_mfma_f32_16x16x32_bf16 v[136:139], v[172:175], v[20:23], v[136:139]
    ds_read_b64_tr_b16 v[176:177], v8 offset:8224
    ds_read_b64_tr_b16 v[178:179], v8 offset:12320
    s_waitcnt lgkmcnt(0)
    v_mfma_f32_16x16x32_bf16 v[140:143], v[176:179], v[20:23], v[140:143]
    ds_read_b64_tr_b16 v[172:173], v8 offset:8256
    ds_read_b64_tr_b16 v[174:175], v8 offset:12352
    s_waitcnt lgkmcnt(0)
    v_mfma_f32_16x16x32_bf16 v[144:147], v[172:175], v[20:23], v[144:147]
    ds_read_b64_tr_b16 v[176:177], v8 offset:8288
    ds_read_b64_tr_b16 v[178:179], v8 offset:12384
    s_waitcnt lgkmcnt(0)
    v_mfma_f32_16x16x32_bf16 v[148:151], v[176:179], v[20:23], v[148:151]
    ds_read_b64_tr_b16 v[172:173], v8 offset:8320
    ds_read_b64_tr_b16 v[174:175], v8 offset:12416
    s_waitcnt lgkmcnt(0)
    v_mfma_f32_16x16x32_bf16 v[152:155], v[172:175], v[20:23], v[152:155]
    ds_read_b64_tr_b16 v[176:177], v8 offset:8352
    ds_read_b64_tr_b16 v[178:179], v8 offset:12448
    s_waitcnt lgkmcnt(0)
    v_mfma_f32_16x16x32_bf16 v[156:159], v[176:179], v[20:23], v[156:159]
    ds_read_b64_tr_b16 v[172:173], v8 offset:8384
    ds_read_b64_tr_b16 v[174:175], v8 offset:12480
    s_waitcnt lgkmcnt(0)
    v_mfma_f32_16x16x32_bf16 v[160:163], v[172:175], v[20:23], v[160:163]
    ds_read_b64_tr_b16 v[176:177], v8 offset:8416
    ds_read_b64_tr_b16 v[178:179], v8 offset:12512
    s_waitcnt lgkmcnt(0)
    v_mfma_f32_16x16x32_bf16 v[164:167], v[176:179], v[20:23], v[164:167]
    s_add_u32 s30, s23, 57344
    s_add_u32 s31, s30, 4096
    buffer_load_dwordx4 v[72:75], v5, s[4:7], s30 offen offset:0 nt
    buffer_load_dwordx4 v[76:79], v5, s[4:7], s30 offen offset:64 nt
    buffer_load_dwordx4 v[80:83], v5, s[4:7], s30 offen offset:128 nt
    buffer_load_dwordx4 v[84:87], v5, s[4:7], s30 offen offset:192 nt
    buffer_load_dwordx4 v[88:91], v5, s[4:7], s31 offen offset:0 nt
    buffer_load_dwordx4 v[92:95], v5, s[4:7], s31 offen offset:64 nt
    buffer_load_dwordx4 v[96:99], v5, s[4:7], s31 offen offset:128 nt
    buffer_load_dwordx4 v[100:103], v5, s[4:7], s31 offen offset:192 nt
    s_add_u32 s32, s29, 8192
    s_mov_b32 m0, s32
    s_nop 0
    buffer_load_dwordx4 v6, s[24:27], s30 offen offset:0 lds
    buffer_load_dwordx4 v6, s[24:27], s30 offen offset:1024 lds
    buffer_load_dwordx4 v6, s[24:27], s30 offen offset:2048 lds
    buffer_load_dwordx4 v6, s[24:27], s30 offen offset:3072 lds
    s_add_u32 s32, s29, 12288
    s_mov_b32 m0, s32
    s_nop 0
    buffer_load_dwordx4 v6, s[24:27], s31 offen offset:0 lds
    buffer_load_dwordx4 v6, s[24:27], s31 offen offset:1024 lds
    buffer_load_dwordx4 v6, s[24:27], s31 offen offset:2048 lds
    buffer_load_dwordx4 v6, s[24:27], s31 offen offset:3072 lds
    s_nop 7
    s_waitcnt vmcnt(24)
    v_mfma_f32_16x16x32_bf16 v[10:13], v[40:43], v[24:27], 0
    v_mfma_f32_16x16x32_bf16 v[10:13], v[44:47], v[28:31], v[10:13]
    v_mfma_f32_16x16x32_bf16 v[10:13], v[48:51], v[32:35], v[10:13]
    v_mfma_f32_16x16x32_bf16 v[10:13], v[52:55], v[36:39], v[10:13]
    v_mfma_f32_16x16x32_bf16 v[14:17], v[56:59], v[24:27], 0
    v_mfma_f32_16x16x32_bf16 v[14:17], v[60:63], v[28:31], v[14:17]
    v_mfma_f32_16x16x32_bf16 v[14:17], v[64:67], v[32:35], v[14:17]
    v_mfma_f32_16x16x32_bf16 v[14:17], v[68:71], v[36:39], v[14:17]
    s_nop 7
    s_nop 1
    v_cvt_pk_bf16_f32 v18, v10, v11
    v_lshlrev_b32 v10, 16, v18
    v_and_b32 v11, 0xffff0000, v18
    v_mul_f32 v10, 1035273459, v10
    v_mul_f32 v11, 1035273459, v11
    v_cvt_pk_bf16_f32 v18, v10, v11
    v_lshlrev_b32 v10, 16, v18
    v_and_b32 v11, 0xffff0000, v18
    v_cvt_pk_bf16_f32 v18, v12, v13
    v_lshlrev_b32 v12, 16, v18
    v_and_b32 v13, 0xffff0000, v18
    v_mul_f32 v12, 1035273459, v12
    v_mul_f32 v13, 1035273459, v13
    v_cvt_pk_bf16_f32 v18, v12, v13
    v_lshlrev_b32 v12, 16, v18
    v_and_b32 v13, 0xffff0000, v18
    v_cvt_pk_bf16_f32 v18, v14, v15
    v_lshlrev_b32 v14, 16, v18
    v_and_b32 v15, 0xffff0000, v18
    v_mul_f32 v14, 1035273459, v14
    v_mul_f32 v15, 1035273459, v15
    v_cvt_pk_bf16_f32 v18, v14, v15
    v_lshlrev_b32 v14, 16, v18
    v_and_b32 v15, 0xffff0000, v18
    v_cvt_pk_bf16_f32 v18, v16, v17
    v_lshlrev_b32 v16, 16, v18
    v_and_b32 v17, 0xffff0000, v18
    v_mul_f32 v16, 1035273459, v16
    v_mul_f32 v17, 1035273459, v17
    v_cvt_pk_bf16_f32 v18, v16, v17
    v_lshlrev_b32 v16, 16, v18
    v_and_b32 v17, 0xffff0000, v18
    v_max3_f32 v18, v10, v11, v12
    v_max3_f32 v19, v13, v14, v15
    v_max3_f32 v18, v18, v16, v17
    v_max_f32 v18, v18, v19
    v_mov_b32 v19, v18
    s_nop 1
    v_permlane32_swap_b32 v18, v19
    v_max_f32 v18, v18, v19
    v_mov_b32 v19, v18
    s_nop 1
    v_permlane16_swap_b32 v18, v19
    v_max_f32 v18, v18, v19
    v_max_f32 v19, v170, v18
    v_sub_f32 v20, v170, v19
    v_mul_f32 v20, 1069066811, v20
    v_exp_f32 v20, v20
    v_mov_b32 v170, v19
    v_sub_f32 v10, v10, v19
    v_mul_f32 v10, 1069066811, v10
    v_exp_f32 v10, v10
    v_sub_f32 v11, v11, v19
    v_mul_f32 v11, 1069066811, v11
    v_exp_f32 v11, v11
    v_sub_f32 v12, v12, v19
    v_mul_f32 v12, 1069066811, v12
    v_exp_f32 v12, v12
    v_sub_f32 v13, v13, v19
    v_mul_f32 v13, 1069066811, v13
    v_exp_f32 v13, v13
    v_sub_f32 v14, v14, v19
    v_mul_f32 v14, 1069066811, v14
    v_exp_f32 v14, v14
    v_sub_f32 v15, v15, v19
    v_mul_f32 v15, 1069066811, v15
    v_exp_f32 v15, v15
    v_sub_f32 v16, v16, v19
    v_mul_f32 v16, 1069066811, v16
    v_exp_f32 v16, v16
    v_sub_f32 v17, v17, v19
    v_mul_f32 v17, 1069066811, v17
    v_exp_f32 v17, v17
    v_mul_f32 v171, v171, v20
    v_add_f32 v171, v171, v10
    v_add_f32 v171, v171, v11
    v_add_f32 v171, v171, v12
    v_add_f32 v171, v171, v13
    v_add_f32 v171, v171, v14
    v_add_f32 v171, v171, v15
    v_add_f32 v171, v171, v16
    v_add_f32 v171, v171, v17
    v_mul_f32 v136, v136, v20
    v_mul_f32 v137, v137, v20
    v_mul_f32 v138, v138, v20
    v_mul_f32 v139, v139, v20
    v_mul_f32 v140, v140, v20
    v_mul_f32 v141, v141, v20
    v_mul_f32 v142, v142, v20
    v_mul_f32 v143, v143, v20
    v_mul_f32 v144, v144, v20
    v_mul_f32 v145, v145, v20
    v_mul_f32 v146, v146, v20
    v_mul_f32 v147, v147, v20
    v_mul_f32 v148, v148, v20
    v_mul_f32 v149, v149, v20
    v_mul_f32 v150, v150, v20
    v_mul_f32 v151, v151, v20
    v_mul_f32 v152, v152, v20
    v_mul_f32 v153, v153, v20
    v_mul_f32 v154, v154, v20
    v_mul_f32 v155, v155, v20
    v_mul_f32 v156, v156, v20
    v_mul_f32 v157, v157, v20
    v_mul_f32 v158, v158, v20
    v_mul_f32 v159, v159, v20
    v_mul_f32 v160, v160, v20
    v_mul_f32 v161, v161, v20
    v_mul_f32 v162, v162, v20
    v_mul_f32 v163, v163, v20
    v_mul_f32 v164, v164, v20
    v_mul_f32 v165, v165, v20
    v_mul_f32 v166, v166, v20
    v_mul_f32 v167, v167, v20
    v_cvt_pk_bf16_f32 v20, v10, v11
    v_cvt_pk_bf16_f32 v21, v12, v13
    v_cvt_pk_bf16_f32 v22, v14, v15
    v_cvt_pk_bf16_f32 v23, v16, v17
    s_waitcnt vmcnt(16)
    ds_read_b64_tr_b16 v[172:173], v8 offset:0
    ds_read_b64_tr_b16 v[174:175], v8 offset:4096
    s_waitcnt lgkmcnt(0)
    v_mfma_f32_16x16x32_bf16 v[136:139], v[172:175], v[20:23], v[136:139]
    ds_read_b64_tr_b16 v[176:177], v8 offset:32
    ds_read_b64_tr_b16 v[178:179], v8 offset:4128
    s_waitcnt lgkmcnt(0)
    v_mfma_f32_16x16x32_bf16 v[140:143], v[176:179], v[20:23], v[140:143]
    ds_read_b64_tr_b16 v[172:173], v8 offset:64
    ds_read_b64_tr_b16 v[174:175], v8 offset:4160
    s_waitcnt lgkmcnt(0)
    v_mfma_f32_16x16x32_bf16 v[144:147], v[172:175], v[20:23], v[144:147]
    ds_read_b64_tr_b16 v[176:177], v8 offset:96
    ds_read_b64_tr_b16 v[178:179], v8 offset:4192
    s_waitcnt lgkmcnt(0)
    v_mfma_f32_16x16x32_bf16 v[148:151], v[176:179], v[20:23], v[148:151]
    ds_read_b64_tr_b16 v[172:173], v8 offset:128
    ds_read_b64_tr_b16 v[174:175], v8 offset:4224
    s_waitcnt lgkmcnt(0)
    v_mfma_f32_16x16x32_bf16 v[152:155], v[172:175], v[20:23], v[152:155]
    ds_read_b64_tr_b16 v[176:177], v8 offset:160
    ds_read_b64_tr_b16 v[178:179], v8 offset:4256
    s_waitcnt lgkmcnt(0)
    v_mfma_f32_16x16x32_bf16 v[156:159], v[176:179], v[20:23], v[156:159]
    ds_read_b64_tr_b16 v[172:173], v8 offset:192
    ds_read_b64_tr_b16 v[174:175], v8 offset:4288
    s_waitcnt lgkmcnt(0)
    v_mfma_f32_16x16x32_bf16 v[160:163], v[172:175], v[20:23], v[160:163]
    ds_read_b64_tr_b16 v[176:177], v8 offset:224
    ds_read_b64_tr_b16 v[178:179], v8 offset:4320
    s_waitcnt lgkmcnt(0)
    v_mfma_f32_16x16x32_bf16 v[164:167], v[176:179], v[20:23], v[164:167]
    s_nop 7
    s_waitcnt vmcnt(8)
    v_mfma_f32_16x16x32_bf16 v[10:13], v[72:75], v[24:27], 0
    v_mfma_f32_16x16x32_bf16 v[10:13], v[76:79], v[28:31], v[10:13]
    v_mfma_f32_16x16x32_bf16 v[10:13], v[80:83], v[32:35], v[10:13]
    v_mfma_f32_16x16x32_bf16 v[10:13], v[84:87], v[36:39], v[10:13]
    v_mfma_f32_16x16x32_bf16 v[14:17], v[88:91], v[24:27], 0
    v_mfma_f32_16x16x32_bf16 v[14:17], v[92:95], v[28:31], v[14:17]
    v_mfma_f32_16x16x32_bf16 v[14:17], v[96:99], v[32:35], v[14:17]
    v_mfma_f32_16x16x32_bf16 v[14:17], v[100:103], v[36:39], v[14:17]
    s_nop 7
    s_nop 1
    v_cvt_pk_bf16_f32 v18, v10, v11
    v_lshlrev_b32 v10, 16, v18
    v_and_b32 v11, 0xffff0000, v18
    v_mul_f32 v10, 1035273459, v10
    v_mul_f32 v11, 1035273459, v11
    v_cvt_pk_bf16_f32 v18, v10, v11
    v_lshlrev_b32 v10, 16, v18
    v_and_b32 v11, 0xffff0000, v18
    v_cvt_pk_bf16_f32 v18, v12, v13
    v_lshlrev_b32 v12, 16, v18
    v_and_b32 v13, 0xffff0000, v18
    v_mul_f32 v12, 1035273459, v12
    v_mul_f32 v13, 1035273459, v13
    v_cvt_pk_bf16_f32 v18, v12, v13
    v_lshlrev_b32 v12, 16, v18
    v_and_b32 v13, 0xffff0000, v18
    v_cvt_pk_bf16_f32 v18, v14, v15
    v_lshlrev_b32 v14, 16, v18
    v_and_b32 v15, 0xffff0000, v18
    v_mul_f32 v14, 1035273459, v14
    v_mul_f32 v15, 1035273459, v15
    v_cvt_pk_bf16_f32 v18, v14, v15
    v_lshlrev_b32 v14, 16, v18
    v_and_b32 v15, 0xffff0000, v18
    v_cvt_pk_bf16_f32 v18, v16, v17
    v_lshlrev_b32 v16, 16, v18
    v_and_b32 v17, 0xffff0000, v18
    v_mul_f32 v16, 1035273459, v16
    v_mul_f32 v17, 1035273459, v17
    v_cvt_pk_bf16_f32 v18, v16, v17
    v_lshlrev_b32 v16, 16, v18
    v_and_b32 v17, 0xffff0000, v18
    v_max3_f32 v18, v10, v11, v12
    v_max3_f32 v19, v13, v14, v15
    v_max3_f32 v18, v18, v16, v17
    v_max_f32 v18, v18, v19
    v_mov_b32 v19, v18
    s_nop 1
    v_permlane32_swap_b32 v18, v19
    v_max_f32 v18, v18, v19
    v_mov_b32 v19, v18
    s_nop 1
    v_permlane16_swap_b32 v18, v19
    v_max_f32 v18, v18, v19
    v_max_f32 v19, v170, v18
    v_sub_f32 v20, v170, v19
    v_mul_f32 v20, 1069066811, v20
    v_exp_f32 v20, v20
    v_mov_b32 v170, v19
    v_sub_f32 v10, v10, v19
    v_mul_f32 v10, 1069066811, v10
    v_exp_f32 v10, v10
    v_sub_f32 v11, v11, v19
    v_mul_f32 v11, 1069066811, v11
    v_exp_f32 v11, v11
    v_sub_f32 v12, v12, v19
    v_mul_f32 v12, 1069066811, v12
    v_exp_f32 v12, v12
    v_sub_f32 v13, v13, v19
    v_mul_f32 v13, 1069066811, v13
    v_exp_f32 v13, v13
    v_sub_f32 v14, v14, v19
    v_mul_f32 v14, 1069066811, v14
    v_exp_f32 v14, v14
    v_sub_f32 v15, v15, v19
    v_mul_f32 v15, 1069066811, v15
    v_exp_f32 v15, v15
    v_sub_f32 v16, v16, v19
    v_mul_f32 v16, 1069066811, v16
    v_exp_f32 v16, v16
    v_sub_f32 v17, v17, v19
    v_mul_f32 v17, 1069066811, v17
    v_exp_f32 v17, v17
    v_mul_f32 v171, v171, v20
    v_add_f32 v171, v171, v10
    v_add_f32 v171, v171, v11
    v_add_f32 v171, v171, v12
    v_add_f32 v171, v171, v13
    v_add_f32 v171, v171, v14
    v_add_f32 v171, v171, v15
    v_add_f32 v171, v171, v16
    v_add_f32 v171, v171, v17
    v_mul_f32 v136, v136, v20
    v_mul_f32 v137, v137, v20
    v_mul_f32 v138, v138, v20
    v_mul_f32 v139, v139, v20
    v_mul_f32 v140, v140, v20
    v_mul_f32 v141, v141, v20
    v_mul_f32 v142, v142, v20
    v_mul_f32 v143, v143, v20
    v_mul_f32 v144, v144, v20
    v_mul_f32 v145, v145, v20
    v_mul_f32 v146, v146, v20
    v_mul_f32 v147, v147, v20
    v_mul_f32 v148, v148, v20
    v_mul_f32 v149, v149, v20
    v_mul_f32 v150, v150, v20
    v_mul_f32 v151, v151, v20
    v_mul_f32 v152, v152, v20
    v_mul_f32 v153, v153, v20
    v_mul_f32 v154, v154, v20
    v_mul_f32 v155, v155, v20
    v_mul_f32 v156, v156, v20
    v_mul_f32 v157, v157, v20
    v_mul_f32 v158, v158, v20
    v_mul_f32 v159, v159, v20
    v_mul_f32 v160, v160, v20
    v_mul_f32 v161, v161, v20
    v_mul_f32 v162, v162, v20
    v_mul_f32 v163, v163, v20
    v_mul_f32 v164, v164, v20
    v_mul_f32 v165, v165, v20
    v_mul_f32 v166, v166, v20
    v_mul_f32 v167, v167, v20
    v_cvt_pk_bf16_f32 v20, v10, v11
    v_cvt_pk_bf16_f32 v21, v12, v13
    v_cvt_pk_bf16_f32 v22, v14, v15
    v_cvt_pk_bf16_f32 v23, v16, v17
    s_waitcnt vmcnt(0)
    ds_read_b64_tr_b16 v[172:173], v8 offset:8192
    ds_read_b64_tr_b16 v[174:175], v8 offset:12288
    s_waitcnt lgkmcnt(0)
    v_mfma_f32_16x16x32_bf16 v[136:139], v[172:175], v[20:23], v[136:139]
    ds_read_b64_tr_b16 v[176:177], v8 offset:8224
    ds_read_b64_tr_b16 v[178:179], v8 offset:12320
    s_waitcnt lgkmcnt(0)
    v_mfma_f32_16x16x32_bf16 v[140:143], v[176:179], v[20:23], v[140:143]
    ds_read_b64_tr_b16 v[172:173], v8 offset:8256
    ds_read_b64_tr_b16 v[174:175], v8 offset:12352
    s_waitcnt lgkmcnt(0)
    v_mfma_f32_16x16x32_bf16 v[144:147], v[172:175], v[20:23], v[144:147]
    ds_read_b64_tr_b16 v[176:177], v8 offset:8288
    ds_read_b64_tr_b16 v[178:179], v8 offset:12384
    s_waitcnt lgkmcnt(0)
    v_mfma_f32_16x16x32_bf16 v[148:151], v[176:179], v[20:23], v[148:151]
    ds_read_b64_tr_b16 v[172:173], v8 offset:8320
    ds_read_b64_tr_b16 v[174:175], v8 offset:12416
    s_waitcnt lgkmcnt(0)
    v_mfma_f32_16x16x32_bf16 v[152:155], v[172:175], v[20:23], v[152:155]
    ds_read_b64_tr_b16 v[176:177], v8 offset:8352
    ds_read_b64_tr_b16 v[178:179], v8 offset:12448
    s_waitcnt lgkmcnt(0)
    v_mfma_f32_16x16x32_bf16 v[156:159], v[176:179], v[20:23], v[156:159]
    ds_read_b64_tr_b16 v[172:173], v8 offset:8384
    ds_read_b64_tr_b16 v[174:175], v8 offset:12480
    s_waitcnt lgkmcnt(0)
    v_mfma_f32_16x16x32_bf16 v[160:163], v[172:175], v[20:23], v[160:163]
    ds_read_b64_tr_b16 v[176:177], v8 offset:8416
    ds_read_b64_tr_b16 v[178:179], v8 offset:12512
    s_waitcnt lgkmcnt(0)
    v_mfma_f32_16x16x32_bf16 v[164:167], v[176:179], v[20:23], v[164:167]
    s_nop 7
    v_mov_b32 v19, v171
    s_nop 1
    v_permlane32_swap_b32 v171, v19
    v_add_f32 v171, v171, v19
    v_mov_b32 v19, v171
    s_nop 1
    v_permlane16_swap_b32 v171, v19
    v_add_f32 v171, v171, v19
    s_barrier
    v_lshlrev_b32 v7, 2, v3
    v_lshl_add_u32 v7, v1, 6, v7
    ds_write_b32 v7, v170 offset:0
    s_waitcnt lgkmcnt(0)
    s_barrier
    v_lshlrev_b32 v7, 2, v3
    ds_read_b32 v10, v7 offset:0
    ds_read_b32 v11, v7 offset:64
    ds_read_b32 v12, v7 offset:128
    ds_read_b32 v13, v7 offset:192
    s_waitcnt lgkmcnt(0)
    v_max3_f32 v14, v10, v11, v12
    v_max_f32 v14, v14, v13
    v_mov_b32 v2, v14
    v_sub_f32 v15, v170, v14
    v_mul_f32 v15, 1069066811, v15
    v_exp_f32 v15, v15
    s_nop 0
    v_mul_f32 v171, v171, v15
    v_mul_f32 v136, v136, v15
    v_mul_f32 v137, v137, v15
    v_mul_f32 v138, v138, v15
    v_mul_f32 v139, v139, v15
    v_mul_f32 v140, v140, v15
    v_mul_f32 v141, v141, v15
    v_mul_f32 v142, v142, v15
    v_mul_f32 v143, v143, v15
    v_mul_f32 v144, v144, v15
    v_mul_f32 v145, v145, v15
    v_mul_f32 v146, v146, v15
    v_mul_f32 v147, v147, v15
    v_mul_f32 v148, v148, v15
    v_mul_f32 v149, v149, v15
    v_mul_f32 v150, v150, v15
    v_mul_f32 v151, v151, v15
    v_mul_f32 v152, v152, v15
    v_mul_f32 v153, v153, v15
    v_mul_f32 v154, v154, v15
    v_mul_f32 v155, v155, v15
    v_mul_f32 v156, v156, v15
    v_mul_f32 v157, v157, v15
    v_mul_f32 v158, v158, v15
    v_mul_f32 v159, v159, v15
    v_mul_f32 v160, v160, v15
    v_mul_f32 v161, v161, v15
    v_mul_f32 v162, v162, v15
    v_mul_f32 v163, v163, v15
    v_mul_f32 v164, v164, v15
    v_mul_f32 v165, v165, v15
    v_mul_f32 v166, v166, v15
    v_mul_f32 v167, v167, v15
    v_lshlrev_b32 v7, 9, v3
    v_lshl_add_u32 v7, v4, 4, v7
    v_lshl_add_u32 v7, v1, 13, v7
    ds_write_b128 v7, v[136:139] offset:2048
    ds_write_b128 v7, v[140:143] offset:2112
    ds_write_b128 v7, v[144:147] offset:2176
    ds_write_b128 v7, v[148:151] offset:2240
    ds_write_b128 v7, v[152:155] offset:2304
    ds_write_b128 v7, v[156:159] offset:2368
    ds_write_b128 v7, v[160:163] offset:2432
    ds_write_b128 v7, v[164:167] offset:2496
    v_lshlrev_b32 v9, 2, v3
    v_lshl_add_u32 v9, v1, 6, v9
    ds_write_b32 v9, v171 offset:1024
    s_waitcnt lgkmcnt(0)
    s_barrier
    v_lshlrev_b32 v7, 4, v0
    ds_read_b128 v[10:13], v7 offset:2048
    ds_read_b128 v[14:17], v7 offset:10240
    ds_read_b128 v[18:21], v7 offset:18432
    ds_read_b128 v[22:25], v7 offset:26624
    s_waitcnt lgkmcnt(0)
    v_add_f32 v10, v10, v14
    v_add_f32 v11, v11, v15
    v_add_f32 v12, v12, v16
    v_add_f32 v13, v13, v17
    v_add_f32 v10, v10, v18
    v_add_f32 v11, v11, v19
    v_add_f32 v12, v12, v20
    v_add_f32 v13, v13, v21
    v_add_f32 v10, v10, v22
    v_add_f32 v11, v11, v23
    v_add_f32 v12, v12, v24
    v_add_f32 v13, v13, v25
    s_lshl_b32 s28, s2, 12
    s_add_u32 s28, s28, 344064
    buffer_store_dwordx4 v[10:13], v7, s[8:11], s28 offen sc0 sc1
    v_cmp_gt_u32 vcc, 8, v0
    s_and_saveexec_b64 s[30:31], vcc
    s_cbranch_execz L_k3_ml
    v_lshlrev_b32 v7, 2, v0
    ds_read_b32 v10, v7 offset:1024
    ds_read_b32 v11, v7 offset:1088
    ds_read_b32 v12, v7 offset:1152
    ds_read_b32 v13, v7 offset:1216
    s_waitcnt lgkmcnt(0)
    v_add_f32 v10, v10, v11
    v_add_f32 v10, v10, v12
    v_add_f32 v10, v10, v13
    s_lshl_b32 s28, s2, 5
    s_add_u32 s33, s28, 335872
    buffer_store_dword v10, v7, s[8:11], s33 offen sc0 sc1
    s_add_u32 s33, s28, 327680
    buffer_store_dword v2, v7, s[8:11], s33 offen sc0 sc1
L_k3_ml:
    s_mov_b64 exec, s[30:31]
L_end_2:
    s_endpgm
.p2align 8
.globl k4_wo_kernel
.type k4_wo_kernel,@function
k4_wo_kernel:
    s_cmp_ge_u32 s2, 256
    s_cbranch_scc1 L_end_3
    s_load_dwordx2 s[12:13], s[0:1], 32
    s_load_dwordx2 s[14:15], s[0:1], 104
    s_waitcnt lgkmcnt(0)
    s_mov_b32 s4, s12
    s_and_b32 s5, s13, 0xffff
    s_mov_b32 s6, 8388608
    s_mov_b32 s7, 0x00020000
    s_mov_b32 s8, s14
    s_and_b32 s9, s15, 0xffff
    s_mov_b32 s10, 268435456
    s_mov_b32 s11, 0x00020000
    s_lshr_b32 s25, s2, 3
    s_and_b32 s26, s2, 7
    s_mul_i32 s20, s25, 262144
    s_lshl_b32 s27, s26, 8
    s_add_u32 s20, s20, s27
    s_lshl_b32 s21, s25, 12
    s_lshl_b32 s27, s26, 9
    s_add_u32 s21, s21, s27
    s_add_u32 s21, s21, 1392640
    v_lshrrev_b32 v1, 4, v0
    v_and_b32 v2, 15, v0
    s_mov_b32 s22, 2048
    v_mul_lo_u32 v3, v1, s22
    v_lshl_add_u32 v3, v2, 4, v3
    s_mov_b32 s23, s20
    buffer_load_dwordx4 v[16:19], v3, s[4:7], s23 offen nt
    s_add_u32 s23, s23, 32768
    buffer_load_dwordx4 v[20:23], v3, s[4:7], s23 offen nt
    s_add_u32 s23, s23, 32768
    buffer_load_dwordx4 v[24:27], v3, s[4:7], s23 offen nt
    s_add_u32 s23, s23, 32768
    buffer_load_dwordx4 v[28:31], v3, s[4:7], s23 offen nt
    s_add_u32 s23, s23, 32768
    buffer_load_dwordx4 v[32:35], v3, s[4:7], s23 offen nt
    s_add_u32 s23, s23, 32768
    buffer_load_dwordx4 v[36:39], v3, s[4:7], s23 offen nt
    s_add_u32 s23, s23, 32768
    buffer_load_dwordx4 v[40:43], v3, s[4:7], s23 offen nt
    s_add_u32 s23, s23, 32768
    buffer_load_dwordx4 v[44:47], v3, s[4:7], s23 offen nt
    s_lshr_b32 s28, s25, 3
    s_and_b32 s29, s25, 7
    v_and_b32 v7, 63, v0
    v_lshlrev_b32 v8, 5, v7
    s_lshl_b32 s24, s28, 11
    s_lshl_b32 s27, s29, 2
    s_add_u32 s24, s24, s27
    s_add_u32 s27, s24, 327680
    buffer_load_dword v9, v8, s[8:11], s27 offen sc0 sc1
    s_add_u32 s27, s24, 335872
    buffer_load_dword v10, v8, s[8:11], s27 offen sc0 sc1
    v_lshlrev_b32 v7, 2, v7
    s_waitcnt vmcnt(0)
    v_mov_b32 v11, v9
    v_xor_b32 v100, 4, v7
    ds_bpermute_b32 v101, v100, v11
    s_waitcnt lgkmcnt(0)
    v_max_f32 v11, v11, v101
    v_xor_b32 v100, 8, v7
    ds_bpermute_b32 v101, v100, v11
    s_waitcnt lgkmcnt(0)
    v_max_f32 v11, v11, v101
    v_xor_b32 v100, 16, v7
    ds_bpermute_b32 v101, v100, v11
    s_waitcnt lgkmcnt(0)
    v_max_f32 v11, v11, v101
    v_xor_b32 v100, 32, v7
    ds_bpermute_b32 v101, v100, v11
    s_waitcnt lgkmcnt(0)
    v_max_f32 v11, v11, v101
    v_xor_b32 v100, 64, v7
    ds_bpermute_b32 v101, v100, v11
    s_waitcnt lgkmcnt(0)
    v_max_f32 v11, v11, v101
    v_xor_b32 v100, 128, v7
    ds_bpermute_b32 v101, v100, v11
    s_waitcnt lgkmcnt(0)
    v_max_f32 v11, v11, v101
    v_sub_f32 v9, v9, v11
    v_mul_f32 v9, 0x3fb8aa3b, v9
    v_exp_f32 v9, v9
    s_nop 0
    v_mul_f32 v10, v10, v9
    v_xor_b32 v100, 4, v7
    ds_bpermute_b32 v101, v100, v10
    s_waitcnt lgkmcnt(0)
    v_add_f32 v10, v10, v101
    v_xor_b32 v100, 8, v7
    ds_bpermute_b32 v101, v100, v10
    s_waitcnt lgkmcnt(0)
    v_add_f32 v10, v10, v101
    v_xor_b32 v100, 16, v7
    ds_bpermute_b32 v101, v100, v10
    s_waitcnt lgkmcnt(0)
    v_add_f32 v10, v10, v101
    v_xor_b32 v100, 32, v7
    ds_bpermute_b32 v101, v100, v10
    s_waitcnt lgkmcnt(0)
    v_add_f32 v10, v10, v101
    v_xor_b32 v100, 64, v7
    ds_bpermute_b32 v101, v100, v10
    s_waitcnt lgkmcnt(0)
    v_add_f32 v10, v10, v101
    v_xor_b32 v100, 128, v7
    ds_bpermute_b32 v101, v100, v10
    s_waitcnt lgkmcnt(0)
    v_add_f32 v10, v10, v101
    v_rcp_f32 v10, v10
    s_nop 0
    v_mul_f32 v9, v9, v10
    ds_write_b32 v7, v9 offset:2048
    s_waitcnt lgkmcnt(0)
    s_barrier
    v_cmp_gt_u32 vcc, 128, v0
    s_and_saveexec_b64 s[30:31], vcc
    s_cbranch_execz L_k4_x
    s_lshl_b32 s24, s28, 18
    s_lshl_b32 s27, s29, 9
    s_add_u32 s24, s24, s27
    s_add_u32 s24, s24, 344064
    v_lshlrev_b32 v8, 2, v0
    v_mov_b32 v12, 0
    v_mov_b32 v11, 0
    s_add_u32 s27, s24, 0
    buffer_load_dword v60, v8, s[8:11], s27 offen sc0 sc1
    s_add_u32 s27, s24, 4096
    buffer_load_dword v61, v8, s[8:11], s27 offen sc0 sc1
    s_add_u32 s27, s24, 8192
    buffer_load_dword v62, v8, s[8:11], s27 offen sc0 sc1
    s_add_u32 s27, s24, 12288
    buffer_load_dword v63, v8, s[8:11], s27 offen sc0 sc1
    s_add_u32 s27, s24, 16384
    buffer_load_dword v64, v8, s[8:11], s27 offen sc0 sc1
    s_add_u32 s27, s24, 20480
    buffer_load_dword v65, v8, s[8:11], s27 offen sc0 sc1
    s_add_u32 s27, s24, 24576
    buffer_load_dword v66, v8, s[8:11], s27 offen sc0 sc1
    s_add_u32 s27, s24, 28672
    buffer_load_dword v67, v8, s[8:11], s27 offen sc0 sc1
    s_add_u32 s27, s24, 32768
    buffer_load_dword v68, v8, s[8:11], s27 offen sc0 sc1
    s_add_u32 s27, s24, 36864
    buffer_load_dword v69, v8, s[8:11], s27 offen sc0 sc1
    s_add_u32 s27, s24, 40960
    buffer_load_dword v70, v8, s[8:11], s27 offen sc0 sc1
    s_add_u32 s27, s24, 45056
    buffer_load_dword v71, v8, s[8:11], s27 offen sc0 sc1
    s_add_u32 s27, s24, 49152
    buffer_load_dword v72, v8, s[8:11], s27 offen sc0 sc1
    s_add_u32 s27, s24, 53248
    buffer_load_dword v73, v8, s[8:11], s27 offen sc0 sc1
    s_add_u32 s27, s24, 57344
    buffer_load_dword v74, v8, s[8:11], s27 offen sc0 sc1
    s_add_u32 s27, s24, 61440
    buffer_load_dword v75, v8, s[8:11], s27 offen sc0 sc1
    s_add_u32 s27, s24, 65536
    buffer_load_dword v76, v8, s[8:11], s27 offen sc0 sc1
    s_add_u32 s27, s24, 69632
    buffer_load_dword v77, v8, s[8:11], s27 offen sc0 sc1
    s_add_u32 s27, s24, 73728
    buffer_load_dword v78, v8, s[8:11], s27 offen sc0 sc1
    s_add_u32 s27, s24, 77824
    buffer_load_dword v79, v8, s[8:11], s27 offen sc0 sc1
    s_add_u32 s27, s24, 81920
    buffer_load_dword v80, v8, s[8:11], s27 offen sc0 sc1
    s_add_u32 s27, s24, 86016
    buffer_load_dword v81, v8, s[8:11], s27 offen sc0 sc1
    s_add_u32 s27, s24, 90112
    buffer_load_dword v82, v8, s[8:11], s27 offen sc0 sc1
    s_add_u32 s27, s24, 94208
    buffer_load_dword v83, v8, s[8:11], s27 offen sc0 sc1
    s_add_u32 s27, s24, 98304
    buffer_load_dword v84, v8, s[8:11], s27 offen sc0 sc1
    s_add_u32 s27, s24, 102400
    buffer_load_dword v85, v8, s[8:11], s27 offen sc0 sc1
    s_add_u32 s27, s24, 106496
    buffer_load_dword v86, v8, s[8:11], s27 offen sc0 sc1
    s_add_u32 s27, s24, 110592
    buffer_load_dword v87, v8, s[8:11], s27 offen sc0 sc1
    s_add_u32 s27, s24, 114688
    buffer_load_dword v88, v8, s[8:11], s27 offen sc0 sc1
    s_add_u32 s27, s24, 118784
    buffer_load_dword v89, v8, s[8:11], s27 offen sc0 sc1
    s_add_u32 s27, s24, 122880
    buffer_load_dword v90, v8, s[8:11], s27 offen sc0 sc1
    s_add_u32 s27, s24, 126976
    buffer_load_dword v91, v8, s[8:11], s27 offen sc0 sc1
    ds_read_b128 v[100:103], v11 offset:2048
    s_waitcnt lgkmcnt(0)
    s_waitcnt vmcnt(28)
    v_fmac_f32 v12, v60, v100
    v_fmac_f32 v12, v61, v101
    v_fmac_f32 v12, v62, v102
    v_fmac_f32 v12, v63, v103
    ds_read_b128 v[100:103], v11 offset:2064
    s_waitcnt lgkmcnt(0)
    s_waitcnt vmcnt(24)
    v_fmac_f32 v12, v64, v100
    v_fmac_f32 v12, v65, v101
    v_fmac_f32 v12, v66, v102
    v_fmac_f32 v12, v67, v103
    ds_read_b128 v[100:103], v11 offset:2080
    s_waitcnt lgkmcnt(0)
    s_waitcnt vmcnt(20)
    v_fmac_f32 v12, v68, v100
    v_fmac_f32 v12, v69, v101
    v_fmac_f32 v12, v70, v102
    v_fmac_f32 v12, v71, v103
    ds_read_b128 v[100:103], v11 offset:2096
    s_waitcnt lgkmcnt(0)
    s_waitcnt vmcnt(16)
    v_fmac_f32 v12, v72, v100
    v_fmac_f32 v12, v73, v101
    v_fmac_f32 v12, v74, v102
    v_fmac_f32 v12, v75, v103
    ds_read_b128 v[100:103], v11 offset:2112
    s_waitcnt lgkmcnt(0)
    s_waitcnt vmcnt(12)
    v_fmac_f32 v12, v76, v100
    v_fmac_f32 v12, v77, v101
    v_fmac_f32 v12, v78, v102
    v_fmac_f32 v12, v79, v103
    ds_read_b128 v[100:103], v11 offset:2128
    s_waitcnt lgkmcnt(0)
    s_waitcnt vmcnt(8)
    v_fmac_f32 v12, v80, v100
    v_fmac_f32 v12, v81, v101
    v_fmac_f32 v12, v82, v102
    v_fmac_f32 v12, v83, v103
    ds_read_b128 v[100:103], v11 offset:2144
    s_waitcnt lgkmcnt(0)
    s_waitcnt vmcnt(4)
    v_fmac_f32 v12, v84, v100
    v_fmac_f32 v12, v85, v101
    v_fmac_f32 v12, v86, v102
    v_fmac_f32 v12, v87, v103
    ds_read_b128 v[100:103], v11 offset:2160
    s_waitcnt lgkmcnt(0)
    s_waitcnt vmcnt(0)
    v_fmac_f32 v12, v88, v100
    v_fmac_f32 v12, v89, v101
    v_fmac_f32 v12, v90, v102
    v_fmac_f32 v12, v91, v103
    s_add_u32 s27, s24, 131072
    buffer_load_dword v60, v8, s[8:11], s27 offen sc0 sc1
    s_add_u32 s27, s24, 135168
    buffer_load_dword v61, v8, s[8:11], s27 offen sc0 sc1
    s_add_u32 s27, s24, 139264
    buffer_load_dword v62, v8, s[8:11], s27 offen sc0 sc1
    s_add_u32 s27, s24, 143360
    buffer_load_dword v63, v8, s[8:11], s27 offen sc0 sc1
    s_add_u32 s27, s24, 147456
    buffer_load_dword v64, v8, s[8:11], s27 offen sc0 sc1
    s_add_u32 s27, s24, 151552
    buffer_load_dword v65, v8, s[8:11], s27 offen sc0 sc1
    s_add_u32 s27, s24, 155648
    buffer_load_dword v66, v8, s[8:11], s27 offen sc0 sc1
    s_add_u32 s27, s24, 159744
    buffer_load_dword v67, v8, s[8:11], s27 offen sc0 sc1
    s_add_u32 s27, s24, 163840
    buffer_load_dword v68, v8, s[8:11], s27 offen sc0 sc1
    s_add_u32 s27, s24, 167936
    buffer_load_dword v69, v8, s[8:11], s27 offen sc0 sc1
    s_add_u32 s27, s24, 172032
    buffer_load_dword v70, v8, s[8:11], s27 offen sc0 sc1
    s_add_u32 s27, s24, 176128
    buffer_load_dword v71, v8, s[8:11], s27 offen sc0 sc1
    s_add_u32 s27, s24, 180224
    buffer_load_dword v72, v8, s[8:11], s27 offen sc0 sc1
    s_add_u32 s27, s24, 184320
    buffer_load_dword v73, v8, s[8:11], s27 offen sc0 sc1
    s_add_u32 s27, s24, 188416
    buffer_load_dword v74, v8, s[8:11], s27 offen sc0 sc1
    s_add_u32 s27, s24, 192512
    buffer_load_dword v75, v8, s[8:11], s27 offen sc0 sc1
    s_add_u32 s27, s24, 196608
    buffer_load_dword v76, v8, s[8:11], s27 offen sc0 sc1
    s_add_u32 s27, s24, 200704
    buffer_load_dword v77, v8, s[8:11], s27 offen sc0 sc1
    s_add_u32 s27, s24, 204800
    buffer_load_dword v78, v8, s[8:11], s27 offen sc0 sc1
    s_add_u32 s27, s24, 208896
    buffer_load_dword v79, v8, s[8:11], s27 offen sc0 sc1
    s_add_u32 s27, s24, 212992
    buffer_load_dword v80, v8, s[8:11], s27 offen sc0 sc1
    s_add_u32 s27, s24, 217088
    buffer_load_dword v81, v8, s[8:11], s27 offen sc0 sc1
    s_add_u32 s27, s24, 221184
    buffer_load_dword v82, v8, s[8:11], s27 offen sc0 sc1
    s_add_u32 s27, s24, 225280
    buffer_load_dword v83, v8, s[8:11], s27 offen sc0 sc1
    s_add_u32 s27, s24, 229376
    buffer_load_dword v84, v8, s[8:11], s27 offen sc0 sc1
    s_add_u32 s27, s24, 233472
    buffer_load_dword v85, v8, s[8:11], s27 offen sc0 sc1
    s_add_u32 s27, s24, 237568
    buffer_load_dword v86, v8, s[8:11], s27 offen sc0 sc1
    s_add_u32 s27, s24, 241664
    buffer_load_dword v87, v8, s[8:11], s27 offen sc0 sc1
    s_add_u32 s27, s24, 245760
    buffer_load_dword v88, v8, s[8:11], s27 offen sc0 sc1
    s_add_u32 s27, s24, 249856
    buffer_load_dword v89, v8, s[8:11], s27 offen sc0 sc1
    s_add_u32 s27, s24, 253952
    buffer_load_dword v90, v8, s[8:11], s27 offen sc0 sc1
    s_add_u32 s27, s24, 258048
    buffer_load_dword v91, v8, s[8:11], s27 offen sc0 sc1
    ds_read_b128 v[100:103], v11 offset:2176
    s_waitcnt lgkmcnt(0)
    s_waitcnt vmcnt(28)
    v_fmac_f32 v12, v60, v100
    v_fmac_f32 v12, v61, v101
    v_fmac_f32 v12, v62, v102
    v_fmac_f32 v12, v63, v103
    ds_read_b128 v[100:103], v11 offset:2192
    s_waitcnt lgkmcnt(0)
    s_waitcnt vmcnt(24)
    v_fmac_f32 v12, v64, v100
    v_fmac_f32 v12, v65, v101
    v_fmac_f32 v12, v66, v102
    v_fmac_f32 v12, v67, v103
    ds_read_b128 v[100:103], v11 offset:2208
    s_waitcnt lgkmcnt(0)
    s_waitcnt vmcnt(20)
    v_fmac_f32 v12, v68, v100
    v_fmac_f32 v12, v69, v101
    v_fmac_f32 v12, v70, v102
    v_fmac_f32 v12, v71, v103
    ds_read_b128 v[100:103], v11 offset:2224
    s_waitcnt lgkmcnt(0)
    s_waitcnt vmcnt(16)
    v_fmac_f32 v12, v72, v100
    v_fmac_f32 v12, v73, v101
    v_fmac_f32 v12, v74, v102
    v_fmac_f32 v12, v75, v103
    ds_read_b128 v[100:103], v11 offset:2240
    s_waitcnt lgkmcnt(0)
    s_waitcnt vmcnt(12)
    v_fmac_f32 v12, v76, v100
    v_fmac_f32 v12, v77, v101
    v_fmac_f32 v12, v78, v102
    v_fmac_f32 v12, v79, v103
    ds_read_b128 v[100:103], v11 offset:2256
    s_waitcnt lgkmcnt(0)
    s_waitcnt vmcnt(8)
    v_fmac_f32 v12, v80, v100
    v_fmac_f32 v12, v81, v101
    v_fmac_f32 v12, v82, v102
    v_fmac_f32 v12, v83, v103
    ds_read_b128 v[100:103], v11 offset:2272
    s_waitcnt lgkmcnt(0)
    s_waitcnt vmcnt(4)
    v_fmac_f32 v12, v84, v100
    v_fmac_f32 v12, v85, v101
    v_fmac_f32 v12, v86, v102
    v_fmac_f32 v12, v87, v103
    ds_read_b128 v[100:103], v11 offset:2288
    s_waitcnt lgkmcnt(0)
    s_waitcnt vmcnt(0)
    v_fmac_f32 v12, v88, v100
    v_fmac_f32 v12, v89, v101
    v_fmac_f32 v12, v90, v102
    v_fmac_f32 v12, v91, v103
    v_cvt_pk_bf16_f32 v100, v12, v12
    v_lshlrev_b32 v12, 16, v100
    ds_write_b32 v8, v12
L_k4_x:
    s_mov_b64 exec, s[30:31]
    s_waitcnt lgkmcnt(0)
    s_barrier
    v_lshlrev_b32 v4, 2, v1
    ds_read_b32 v48, v4 offset:0
    ds_read_b32 v49, v4 offset:64
    ds_read_b32 v50, v4 offset:128
    ds_read_b32 v51, v4 offset:192
    ds_read_b32 v52, v4 offset:256
    ds_read_b32 v53, v4 offset:320
    ds_read_b32 v54, v4 offset:384
    ds_read_b32 v55, v4 offset:448
    v_mov_b32 v56, 0
    v_mov_b32 v57, 0
    v_mov_b32 v58, 0
    v_mov_b32 v59, 0
    v_mov_b32 v60, 0
    v_mov_b32 v61, 0
    v_mov_b32 v62, 0
    v_mov_b32 v63, 0
    s_waitcnt lgkmcnt(0)
    s_waitcnt vmcnt(7)
    v_lshlrev_b32 v5, 16, v16
    v_and_b32 v6, 0xffff0000, v16
    v_fmac_f32 v56, v5, v48
    v_fmac_f32 v57, v6, v48
    v_lshlrev_b32 v5, 16, v17
    v_and_b32 v6, 0xffff0000, v17
    v_fmac_f32 v58, v5, v48
    v_fmac_f32 v59, v6, v48
    v_lshlrev_b32 v5, 16, v18
    v_and_b32 v6, 0xffff0000, v18
    v_fmac_f32 v60, v5, v48
    v_fmac_f32 v61, v6, v48
    v_lshlrev_b32 v5, 16, v19
    v_and_b32 v6, 0xffff0000, v19
    v_fmac_f32 v62, v5, v48
    v_fmac_f32 v63, v6, v48
    s_waitcnt vmcnt(6)
    v_lshlrev_b32 v5, 16, v20
    v_and_b32 v6, 0xffff0000, v20
    v_fmac_f32 v56, v5, v49
    v_fmac_f32 v57, v6, v49
    v_lshlrev_b32 v5, 16, v21
    v_and_b32 v6, 0xffff0000, v21
    v_fmac_f32 v58, v5, v49
    v_fmac_f32 v59, v6, v49
    v_lshlrev_b32 v5, 16, v22
    v_and_b32 v6, 0xffff0000, v22
    v_fmac_f32 v60, v5, v49
    v_fmac_f32 v61, v6, v49
    v_lshlrev_b32 v5, 16, v23
    v_and_b32 v6, 0xffff0000, v23
    v_fmac_f32 v62, v5, v49
    v_fmac_f32 v63, v6, v49
    s_waitcnt vmcnt(5)
    v_lshlrev_b32 v5, 16, v24
    v_and_b32 v6, 0xffff0000, v24
    v_fmac_f32 v56, v5, v50
    v_fmac_f32 v57, v6, v50
    v_lshlrev_b32 v5, 16, v25
    v_and_b32 v6, 0xffff0000, v25
    v_fmac_f32 v58, v5, v50
    v_fmac_f32 v59, v6, v50
    v_lshlrev_b32 v5, 16, v26
    v_and_b32 v6, 0xffff0000, v26
    v_fmac_f32 v60, v5, v50
    v_fmac_f32 v61, v6, v50
    v_lshlrev_b32 v5, 16, v27
    v_and_b32 v6, 0xffff0000, v27
    v_fmac_f32 v62, v5, v50
    v_fmac_f32 v63, v6, v50
    s_waitcnt vmcnt(4)
    v_lshlrev_b32 v5, 16, v28
    v_and_b32 v6, 0xffff0000, v28
    v_fmac_f32 v56, v5, v51
    v_fmac_f32 v57, v6, v51
    v_lshlrev_b32 v5, 16, v29
    v_and_b32 v6, 0xffff0000, v29
    v_fmac_f32 v58, v5, v51
    v_fmac_f32 v59, v6, v51
    v_lshlrev_b32 v5, 16, v30
    v_and_b32 v6, 0xffff0000, v30
    v_fmac_f32 v60, v5, v51
    v_fmac_f32 v61, v6, v51
    v_lshlrev_b32 v5, 16, v31
    v_and_b32 v6, 0xffff0000, v31
    v_fmac_f32 v62, v5, v51
    v_fmac_f32 v63, v6, v51
    s_waitcnt vmcnt(3)
    v_lshlrev_b32 v5, 16, v32
    v_and_b32 v6, 0xffff0000, v32
    v_fmac_f32 v56, v5, v52
    v_fmac_f32 v57, v6, v52
    v_lshlrev_b32 v5, 16, v33
    v_and_b32 v6, 0xffff0000, v33
    v_fmac_f32 v58, v5, v52
    v_fmac_f32 v59, v6, v52
    v_lshlrev_b32 v5, 16, v34
    v_and_b32 v6, 0xffff0000, v34
    v_fmac_f32 v60, v5, v52
    v_fmac_f32 v61, v6, v52
    v_lshlrev_b32 v5, 16, v35
    v_and_b32 v6, 0xffff0000, v35
    v_fmac_f32 v62, v5, v52
    v_fmac_f32 v63, v6, v52
    s_waitcnt vmcnt(2)
    v_lshlrev_b32 v5, 16, v36
    v_and_b32 v6, 0xffff0000, v36
    v_fmac_f32 v56, v5, v53
    v_fmac_f32 v57, v6, v53
    v_lshlrev_b32 v5, 16, v37
    v_and_b32 v6, 0xffff0000, v37
    v_fmac_f32 v58, v5, v53
    v_fmac_f32 v59, v6, v53
    v_lshlrev_b32 v5, 16, v38
    v_and_b32 v6, 0xffff0000, v38
    v_fmac_f32 v60, v5, v53
    v_fmac_f32 v61, v6, v53
    v_lshlrev_b32 v5, 16, v39
    v_and_b32 v6, 0xffff0000, v39
    v_fmac_f32 v62, v5, v53
    v_fmac_f32 v63, v6, v53
    s_waitcnt vmcnt(1)
    v_lshlrev_b32 v5, 16, v40
    v_and_b32 v6, 0xffff0000, v40
    v_fmac_f32 v56, v5, v54
    v_fmac_f32 v57, v6, v54
    v_lshlrev_b32 v5, 16, v41
    v_and_b32 v6, 0xffff0000, v41
    v_fmac_f32 v58, v5, v54
    v_fmac_f32 v59, v6, v54
    v_lshlrev_b32 v5, 16, v42
    v_and_b32 v6, 0xffff0000, v42
    v_fmac_f32 v60, v5, v54
    v_fmac_f32 v61, v6, v54
    v_lshlrev_b32 v5, 16, v43
    v_and_b32 v6, 0xffff0000, v43
    v_fmac_f32 v62, v5, v54
    v_fmac_f32 v63, v6, v54
    s_waitcnt vmcnt(0)
    v_lshlrev_b32 v5, 16, v44
    v_and_b32 v6, 0xffff0000, v44
    v_fmac_f32 v56, v5, v55
    v_fmac_f32 v57, v6, v55
    v_lshlrev_b32 v5, 16, v45
    v_and_b32 v6, 0xffff0000, v45
    v_fmac_f32 v58, v5, v55
    v_fmac_f32 v59, v6, v55
    v_lshlrev_b32 v5, 16, v46
    v_and_b32 v6, 0xffff0000, v46
    v_fmac_f32 v60, v5, v55
    v_fmac_f32 v61, v6, v55
    v_lshlrev_b32 v5, 16, v47
    v_and_b32 v6, 0xffff0000, v47
    v_fmac_f32 v62, v5, v55
    v_fmac_f32 v63, v6, v55
    v_lshlrev_b32 v4, 9, v1
    v_lshl_add_u32 v4, v2, 5, v4
    ds_write_b128 v4, v[56:59] offset:4096
    ds_write_b128 v4, v[60:63] offset:4112
    s_waitcnt lgkmcnt(0)
    s_barrier
    v_cmp_gt_u32 vcc, 128, v0
    s_and_saveexec_b64 s[30:31], vcc
    s_cbranch_execz L_3041
    v_lshlrev_b32 v4, 2, v0
    ds_read_b32 v16, v4 offset:4096
    ds_read_b32 v17, v4 offset:4608
    ds_read_b32 v18, v4 offset:5120
    ds_read_b32 v19, v4 offset:5632
    ds_read_b32 v20, v4 offset:6144
    ds_read_b32 v21, v4 offset:6656
    ds_read_b32 v22, v4 offset:7168
    ds_read_b32 v23, v4 offset:7680
    ds_read_b32 v24, v4 offset:8192
    ds_read_b32 v25, v4 offset:8704
    ds_read_b32 v26, v4 offset:9216
    ds_read_b32 v27, v4 offset:9728
    ds_read_b32 v28, v4 offset:10240
    ds_read_b32 v29, v4 offset:10752
    ds_read_b32 v30, v4 offset:11264
    ds_read_b32 v31, v4 offset:11776
    s_waitcnt lgkmcnt(0)
    v_add_f32 v16, v16, v17
    v_add_f32 v16, v16, v18
    v_add_f32 v16, v16, v19
    v_add_f32 v16, v16, v20
    v_add_f32 v16, v16, v21
    v_add_f32 v16, v16, v22
    v_add_f32 v16, v16, v23
    v_add_f32 v16, v16, v24
    v_add_f32 v16, v16, v25
    v_add_f32 v16, v16, v26
    v_add_f32 v16, v16, v27
    v_add_f32 v16, v16, v28
    v_add_f32 v16, v16, v29
    v_add_f32 v16, v16, v30
    v_add_f32 v16, v16, v31
    buffer_store_dword v16, v4, s[8:11], s21 offen sc0 sc1
L_3041:
    s_mov_b64 exec, s[30:31]
L_end_3:
    s_endpgm
.p2align 8
.globl k5_gu_kernel
.type k5_gu_kernel,@function
k5_gu_kernel:
    s_cmp_ge_u32 s2, 224
    s_cbranch_scc1 L_end_4
    s_load_dwordx2 s[12:13], s[0:1], 48
    s_load_dwordx2 s[14:15], s[0:1], 104
    s_load_dwordx2 s[16:17], s[0:1], 0
    s_load_dwordx2 s[18:19], s[0:1], 56
    s_waitcnt lgkmcnt(0)
    s_mul_hi_u32 s25, s2, 0x924924a
    s_mul_i32 s26, s25, 28
    s_sub_u32 s26, s2, s26
    s_and_b32 s28, s25, 3
    s_cmp_ge_u32 s25, 4
    s_cselect_b32 s12, s18, s12
    s_cselect_b32 s13, s19, s13
    s_mov_b32 s4, s12
    s_and_b32 s5, s13, 0xffff
    s_mov_b32 s6, 7340032
    s_mov_b32 s7, 0x00020000
    s_mov_b32 s8, s14
    s_and_b32 s9, s15, 0xffff
    s_mov_b32 s10, 268435456
    s_mov_b32 s11, 0x00020000
    s_mov_b32 s12, s16
    s_and_b32 s13, s17, 0xffff
    s_mov_b32 s14, 2048
    s_mov_b32 s15, 0x00020000
    s_mul_i32 s20, s28, 1835008
    s_lshl_b32 s27, s26, 8
    s_add_u32 s20, s20, s27
    s_mul_i32 s21, s25, 3584*4
    s_lshl_b32 s27, s26, 9
    s_add_u32 s21, s21, s27
    s_add_u32 s21, s21, 1523712
    v_lshrrev_b32 v1, 4, v0
    v_and_b32 v2, 15, v0
    s_mov_b32 s22, 7168
    v_mul_lo_u32 v3, v1, s22
    v_lshl_add_u32 v3, v2, 4, v3
    s_mov_b32 s23, s20
    buffer_load_dwordx4 v[16:19], v3, s[4:7], s23 offen nt
    s_add_u32 s23, s23, 114688
    buffer_load_dwordx4 v[20:23], v3, s[4:7], s23 offen nt
    s_add_u32 s23, s23, 114688
    buffer_load_dwordx4 v[24:27], v3, s[4:7], s23 offen nt
    s_add_u32 s23, s23, 114688
    buffer_load_dwordx4 v[28:31], v3, s[4:7], s23 offen nt
    s_add_u32 s23, s23, 114688
    buffer_load_dwordx4 v[32:35], v3, s[4:7], s23 offen nt
    s_add_u32 s23, s23, 114688
    buffer_load_dwordx4 v[36:39], v3, s[4:7], s23 offen nt
    s_add_u32 s23, s23, 114688
    buffer_load_dwordx4 v[40:43], v3, s[4:7], s23 offen nt
    s_add_u32 s23, s23, 114688
    buffer_load_dwordx4 v[44:47], v3, s[4:7], s23 offen nt
    s_add_u32 s23, s23, 114688
    buffer_load_dwordx4 v[48:51], v3, s[4:7], s23 offen nt
    s_add_u32 s23, s23, 114688
    buffer_load_dwordx4 v[52:55], v3, s[4:7], s23 offen nt
    s_add_u32 s23, s23, 114688
    buffer_load_dwordx4 v[56:59], v3, s[4:7], s23 offen nt
    s_add_u32 s23, s23, 114688
    buffer_load_dwordx4 v[60:63], v3, s[4:7], s23 offen nt
    s_add_u32 s23, s23, 114688
    buffer_load_dwordx4 v[64:67], v3, s[4:7], s23 offen nt
    s_add_u32 s23, s23, 114688
    buffer_load_dwordx4 v[68:71], v3, s[4:7], s23 offen nt
    s_add_u32 s23, s23, 114688
    buffer_load_dwordx4 v[72:75], v3, s[4:7], s23 offen nt
    s_add_u32 s23, s23, 114688
    buffer_load_dwordx4 v[76:79], v3, s[4:7], s23 offen nt
    v_lshlrev_b32 v8, 4, v0
    v_mov_b32 v100, 0
    v_mov_b32 v101, 0
    v_mov_b32 v102, 0
    v_mov_b32 v103, 0
    s_mov_b32 s24, 1392640
    buffer_load_dwordx4 v[112:115], v8, s[8:11], s24 offen sc0 sc1
    s_mov_b32 s24, 1396736
    buffer_load_dwordx4 v[116:119], v8, s[8:11], s24 offen sc0 sc1
    s_mov_b32 s24, 1400832
    buffer_load_dwordx4 v[120:123], v8, s[8:11], s24 offen sc0 sc1
    s_mov_b32 s24, 1404928
    buffer_load_dwordx4 v[124:127], v8, s[8:11], s24 offen sc0 sc1
    s_mov_b32 s24, 1409024
    buffer_load_dwordx4 v[128:131], v8, s[8:11], s24 offen sc0 sc1
    s_mov_b32 s24, 1413120
    buffer_load_dwordx4 v[132:135], v8, s[8:11], s24 offen sc0 sc1
    s_mov_b32 s24, 1417216
    buffer_load_dwordx4 v[136:139], v8, s[8:11], s24 offen sc0 sc1
    s_mov_b32 s24, 1421312
    buffer_load_dwordx4 v[140:143], v8, s[8:11], s24 offen sc0 sc1
    s_mov_b32 s24, 1425408
    buffer_load_dwordx4 v[144:147], v8, s[8:11], s24 offen sc0 sc1
    s_mov_b32 s24, 1429504
    buffer_load_dwordx4 v[148:151], v8, s[8:11], s24 offen sc0 sc1
    s_mov_b32 s24, 1433600
    buffer_load_dwordx4 v[152:155], v8, s[8:11], s24 offen sc0 sc1
    s_mov_b32 s24, 1437696
    buffer_load_dwordx4 v[156:159], v8, s[8:11], s24 offen sc0 sc1
    s_mov_b32 s24, 1441792
    buffer_load_dwordx4 v[160:163], v8, s[8:11], s24 offen sc0 sc1
    s_mov_b32 s24, 1445888
    buffer_load_dwordx4 v[164:167], v8, s[8:11], s24 offen sc0 sc1
    s_mov_b32 s24, 1449984
    buffer_load_dwordx4 v[168:171], v8, s[8:11], s24 offen sc0 sc1
    s_mov_b32 s24, 1454080
    buffer_load_dwordx4 v[172:175], v8, s[8:11], s24 offen sc0 sc1
    s_waitcnt vmcnt(15)
    v_add_f32 v100, v100, v112
    v_add_f32 v101, v101, v113
    v_add_f32 v102, v102, v114
    v_add_f32 v103, v103, v115
    s_waitcnt vmcnt(14)
    v_add_f32 v100, v100, v116
    v_add_f32 v101, v101, v117
    v_add_f32 v102, v102, v118
    v_add_f32 v103, v103, v119
    s_waitcnt vmcnt(13)
    v_add_f32 v100, v100, v120
    v_add_f32 v101, v101, v121
    v_add_f32 v102, v102, v122
    v_add_f32 v103, v103, v123
    s_waitcnt vmcnt(12)
    v_add_f32 v100, v100, v124
    v_add_f32 v101, v101, v125
    v_add_f32 v102, v102, v126
    v_add_f32 v103, v103, v127
    s_waitcnt vmcnt(11)
    v_add_f32 v100, v100, v128
    v_add_f32 v101, v101, v129
    v_add_f32 v102, v102, v130
    v_add_f32 v103, v103, v131
    s_waitcnt vmcnt(10)
    v_add_f32 v100, v100, v132
    v_add_f32 v101, v101, v133
    v_add_f32 v102, v102, v134
    v_add_f32 v103, v103, v135
    s_waitcnt vmcnt(9)
    v_add_f32 v100, v100, v136
    v_add_f32 v101, v101, v137
    v_add_f32 v102, v102, v138
    v_add_f32 v103, v103, v139
    s_waitcnt vmcnt(8)
    v_add_f32 v100, v100, v140
    v_add_f32 v101, v101, v141
    v_add_f32 v102, v102, v142
    v_add_f32 v103, v103, v143
    s_waitcnt vmcnt(7)
    v_add_f32 v100, v100, v144
    v_add_f32 v101, v101, v145
    v_add_f32 v102, v102, v146
    v_add_f32 v103, v103, v147
    s_waitcnt vmcnt(6)
    v_add_f32 v100, v100, v148
    v_add_f32 v101, v101, v149
    v_add_f32 v102, v102, v150
    v_add_f32 v103, v103, v151
    s_waitcnt vmcnt(5)
    v_add_f32 v100, v100, v152
    v_add_f32 v101, v101, v153
    v_add_f32 v102, v102, v154
    v_add_f32 v103, v103, v155
    s_waitcnt vmcnt(4)
    v_add_f32 v100, v100, v156
    v_add_f32 v101, v101, v157
    v_add_f32 v102, v102, v158
    v_add_f32 v103, v103, v159
    s_waitcnt vmcnt(3)
    v_add_f32 v100, v100, v160
    v_add_f32 v101, v101, v161
    v_add_f32 v102, v102, v162
    v_add_f32 v103, v103, v163
    s_waitcnt vmcnt(2)
    v_add_f32 v100, v100, v164
    v_add_f32 v101, v101, v165
    v_add_f32 v102, v102, v166
    v_add_f32 v103, v103, v167
    s_waitcnt vmcnt(1)
    v_add_f32 v100, v100, v168
    v_add_f32 v101, v101, v169
    v_add_f32 v102, v102, v170
    v_add_f32 v103, v103, v171
    s_waitcnt vmcnt(0)
    v_add_f32 v100, v100, v172
    v_add_f32 v101, v101, v173
    v_add_f32 v102, v102, v174
    v_add_f32 v103, v103, v175
    s_mov_b32 s24, 1458176
    buffer_load_dwordx4 v[112:115], v8, s[8:11], s24 offen sc0 sc1
    s_mov_b32 s24, 1462272
    buffer_load_dwordx4 v[116:119], v8, s[8:11], s24 offen sc0 sc1
    s_mov_b32 s24, 1466368
    buffer_load_dwordx4 v[120:123], v8, s[8:11], s24 offen sc0 sc1
    s_mov_b32 s24, 1470464
    buffer_load_dwordx4 v[124:127], v8, s[8:11], s24 offen sc0 sc1
    s_mov_b32 s24, 1474560
    buffer_load_dwordx4 v[128:131], v8, s[8:11], s24 offen sc0 sc1
    s_mov_b32 s24, 1478656
    buffer_load_dwordx4 v[132:135], v8, s[8:11], s24 offen sc0 sc1
    s_mov_b32 s24, 1482752
    buffer_load_dwordx4 v[136:139], v8, s[8:11], s24 offen sc0 sc1
    s_mov_b32 s24, 1486848
    buffer_load_dwordx4 v[140:143], v8, s[8:11], s24 offen sc0 sc1
    s_mov_b32 s24, 1490944
    buffer_load_dwordx4 v[144:147], v8, s[8:11], s24 offen sc0 sc1
    s_mov_b32 s24, 1495040
    buffer_load_dwordx4 v[148:151], v8, s[8:11], s24 offen sc0 sc1
    s_mov_b32 s24, 1499136
    buffer_load_dwordx4 v[152:155], v8, s[8:11], s24 offen sc0 sc1
    s_mov_b32 s24, 1503232
    buffer_load_dwordx4 v[156:159], v8, s[8:11], s24 offen sc0 sc1
    s_mov_b32 s24, 1507328
    buffer_load_dwordx4 v[160:163], v8, s[8:11], s24 offen sc0 sc1
    s_mov_b32 s24, 1511424
    buffer_load_dwordx4 v[164:167], v8, s[8:11], s24 offen sc0 sc1
    s_mov_b32 s24, 1515520
    buffer_load_dwordx4 v[168:171], v8, s[8:11], s24 offen sc0 sc1
    s_mov_b32 s24, 1519616
    buffer_load_dwordx4 v[172:175], v8, s[8:11], s24 offen sc0 sc1
    s_waitcnt vmcnt(15)
    v_add_f32 v100, v100, v112
    v_add_f32 v101, v101, v113
    v_add_f32 v102, v102, v114
    v_add_f32 v103, v103, v115
    s_waitcnt vmcnt(14)
    v_add_f32 v100, v100, v116
    v_add_f32 v101, v101, v117
    v_add_f32 v102, v102, v118
    v_add_f32 v103, v103, v119
    s_waitcnt vmcnt(13)
    v_add_f32 v100, v100, v120
    v_add_f32 v101, v101, v121
    v_add_f32 v102, v102, v122
    v_add_f32 v103, v103, v123
    s_waitcnt vmcnt(12)
    v_add_f32 v100, v100, v124
    v_add_f32 v101, v101, v125
    v_add_f32 v102, v102, v126
    v_add_f32 v103, v103, v127
    s_waitcnt vmcnt(11)
    v_add_f32 v100, v100, v128
    v_add_f32 v101, v101, v129
    v_add_f32 v102, v102, v130
    v_add_f32 v103, v103, v131
    s_waitcnt vmcnt(10)
    v_add_f32 v100, v100, v132
    v_add_f32 v101, v101, v133
    v_add_f32 v102, v102, v134
    v_add_f32 v103, v103, v135
    s_waitcnt vmcnt(9)
    v_add_f32 v100, v100, v136
    v_add_f32 v101, v101, v137
    v_add_f32 v102, v102, v138
    v_add_f32 v103, v103, v139
    s_waitcnt vmcnt(8)
    v_add_f32 v100, v100, v140
    v_add_f32 v101, v101, v141
    v_add_f32 v102, v102, v142
    v_add_f32 v103, v103, v143
    s_waitcnt vmcnt(7)
    v_add_f32 v100, v100, v144
    v_add_f32 v101, v101, v145
    v_add_f32 v102, v102, v146
    v_add_f32 v103, v103, v147
    s_waitcnt vmcnt(6)
    v_add_f32 v100, v100, v148
    v_add_f32 v101, v101, v149
    v_add_f32 v102, v102, v150
    v_add_f32 v103, v103, v151
    s_waitcnt vmcnt(5)
    v_add_f32 v100, v100, v152
    v_add_f32 v101, v101, v153
    v_add_f32 v102, v102, v154
    v_add_f32 v103, v103, v155
    s_waitcnt vmcnt(4)
    v_add_f32 v100, v100, v156
    v_add_f32 v101, v101, v157
    v_add_f32 v102, v102, v158
    v_add_f32 v103, v103, v159
    s_waitcnt vmcnt(3)
    v_add_f32 v100, v100, v160
    v_add_f32 v101, v101, v161
    v_add_f32 v102, v102, v162
    v_add_f32 v103, v103, v163
    s_waitcnt vmcnt(2)
    v_add_f32 v100, v100, v164
    v_add_f32 v101, v101, v165
    v_add_f32 v102, v102, v166
    v_add_f32 v103, v103, v167
    s_waitcnt vmcnt(1)
    v_add_f32 v100, v100, v168
    v_add_f32 v101, v101, v169
    v_add_f32 v102, v102, v170
    v_add_f32 v103, v103, v171
    s_waitcnt vmcnt(0)
    v_add_f32 v100, v100, v172
    v_add_f32 v101, v101, v173
    v_add_f32 v102, v102, v174
    v_add_f32 v103, v103, v175
    s_mov_b32 s24, 8192
    buffer_load_dwordx4 v[112:115], v8, s[8:11], s24 offen sc0 sc1
    s_mov_b32 s24, 32768
    buffer_load_dwordx4 v[116:119], v8, s[8:11], s24 offen sc0 sc1
    s_mov_b32 s24, 57344
    buffer_load_dwordx4 v[120:123], v8, s[8:11], s24 offen sc0 sc1
    s_mov_b32 s24, 81920
    buffer_load_dwordx4 v[124:127], v8, s[8:11], s24 offen sc0 sc1
    s_mov_b32 s24, 106496
    buffer_load_dwordx4 v[128:131], v8, s[8:11], s24 offen sc0 sc1
    s_mov_b32 s24, 131072
    buffer_load_dwordx4 v[132:135], v8, s[8:11], s24 offen sc0 sc1
    s_mov_b32 s24, 155648
    buffer_load_dwordx4 v[136:139], v8, s[8:11], s24 offen sc0 sc1
    s_mov_b32 s24, 180224
    buffer_load_dwordx4 v[140:143], v8, s[8:11], s24 offen sc0 sc1
    v_lshlrev_b32 v9, 3, v0
    buffer_load_dwordx2 v[10:11], v9, s[12:15], 0 offen
    s_waitcnt vmcnt(0)
    v_add_f32 v112, v112, v116
    v_add_f32 v113, v113, v117
    v_add_f32 v114, v114, v118
    v_add_f32 v115, v115, v119
    v_add_f32 v112, v112, v120
    v_add_f32 v113, v113, v121
    v_add_f32 v114, v114, v122
    v_add_f32 v115, v115, v123
    v_add_f32 v112, v112, v124
    v_add_f32 v113, v113, v125
    v_add_f32 v114, v114, v126
    v_add_f32 v115, v115, v127
    v_add_f32 v112, v112, v128
    v_add_f32 v113, v113, v129
    v_add_f32 v114, v114, v130
    v_add_f32 v115, v115, v131
    v_add_f32 v112, v112, v132
    v_add_f32 v113, v113, v133
    v_add_f32 v114, v114, v134
    v_add_f32 v115, v115, v135
    v_add_f32 v112, v112, v136
    v_add_f32 v113, v113, v137
    v_add_f32 v114, v114, v138
    v_add_f32 v115, v115, v139
    v_add_f32 v112, v112, v140
    v_add_f32 v113, v113, v141
    v_add_f32 v114, v114, v142
    v_add_f32 v115, v115, v143
    v_and_b32 v13, 0xffff0000, v11
    v_lshlrev_b32 v12, 16, v11
    v_and_b32 v11, 0xffff0000, v10
    v_lshlrev_b32 v10, 16, v10
    v_cvt_pk_bf16_f32 v104, v100, v100
    v_lshlrev_b32 v100, 16, v104
    v_cvt_pk_bf16_f32 v104, v112, v112
    v_lshlrev_b32 v112, 16, v104
    v_mul_f32 v100, v100, v112
    v_cvt_pk_bf16_f32 v104, v100, v100
    v_lshlrev_b32 v100, 16, v104
    v_add_f32 v10, v10, v100
    v_cvt_pk_bf16_f32 v104, v10, v10
    v_lshlrev_b32 v10, 16, v104
    v_cvt_pk_bf16_f32 v104, v101, v101
    v_lshlrev_b32 v101, 16, v104
    v_cvt_pk_bf16_f32 v104, v113, v113
    v_lshlrev_b32 v113, 16, v104
    v_mul_f32 v101, v101, v113
    v_cvt_pk_bf16_f32 v104, v101, v101
    v_lshlrev_b32 v101, 16, v104
    v_add_f32 v11, v11, v101
    v_cvt_pk_bf16_f32 v104, v11, v11
    v_lshlrev_b32 v11, 16, v104
    v_cvt_pk_bf16_f32 v104, v102, v102
    v_lshlrev_b32 v102, 16, v104
    v_cvt_pk_bf16_f32 v104, v114, v114
    v_lshlrev_b32 v114, 16, v104
    v_mul_f32 v102, v102, v114
    v_cvt_pk_bf16_f32 v104, v102, v102
    v_lshlrev_b32 v102, 16, v104
    v_add_f32 v12, v12, v102
    v_cvt_pk_bf16_f32 v104, v12, v12
    v_lshlrev_b32 v12, 16, v104
    v_cvt_pk_bf16_f32 v104, v103, v103
    v_lshlrev_b32 v103, 16, v104
    v_cvt_pk_bf16_f32 v104, v115, v115
    v_lshlrev_b32 v115, 16, v104
    v_mul_f32 v103, v103, v115
    v_cvt_pk_bf16_f32 v104, v103, v103
    v_lshlrev_b32 v103, 16, v104
    v_add_f32 v13, v13, v103
    v_cvt_pk_bf16_f32 v104, v13, v13
    v_lshlrev_b32 v13, 16, v104
    ds_write_b128 v8, v[10:13] offset:12288
    s_mov_b32 s24, 1753088
    buffer_store_dwordx4 v[10:13], v8, s[8:11], s24 offen sc0 sc1
    v_and_b32 v7, 63, v0
    v_lshlrev_b32 v7, 2, v7
    v_add_f32 v106, v10, v11
    v_add_f32 v107, v12, v13
    v_add_f32 v14, v106, v107
    v_xor_b32 v104, 4, v7
    ds_bpermute_b32 v105, v104, v14
    s_waitcnt lgkmcnt(0)
    v_add_f32 v14, v14, v105
    v_xor_b32 v104, 8, v7
    ds_bpermute_b32 v105, v104, v14
    s_waitcnt lgkmcnt(0)
    v_add_f32 v14, v14, v105
    v_xor_b32 v104, 16, v7
    ds_bpermute_b32 v105, v104, v14
    s_waitcnt lgkmcnt(0)
    v_add_f32 v14, v14, v105
    v_xor_b32 v104, 32, v7
    ds_bpermute_b32 v105, v104, v14
    s_waitcnt lgkmcnt(0)
    v_add_f32 v14, v14, v105
    v_xor_b32 v104, 64, v7
    ds_bpermute_b32 v105, v104, v14
    s_waitcnt lgkmcnt(0)
    v_add_f32 v14, v14, v105
    v_xor_b32 v104, 128, v7
    ds_bpermute_b32 v105, v104, v14
    s_waitcnt lgkmcnt(0)
    v_add_f32 v14, v14, v105
    v_lshrrev_b32 v104, 6, v0
    v_lshlrev_b32 v104, 2, v104
    ds_write_b32 v104, v14 offset:2048
    s_waitcnt lgkmcnt(0)
    s_barrier
    v_mov_b32 v104, 0
    ds_read_b128 v[108:111], v104 offset:2048
    s_waitcnt lgkmcnt(0)
    v_add_f32 v14, v108, v109
    v_add_f32 v14, v14, v110
    v_add_f32 v14, v14, v111
    v_mul_f32 v14, 0x3a800000, v14
    v_mov_b32 v15, 0
    v_sub_f32 v106, v10, v14
    v_fmac_f32 v15, v106, v106
    v_sub_f32 v106, v11, v14
    v_fmac_f32 v15, v106, v106
    v_sub_f32 v106, v12, v14
    v_fmac_f32 v15, v106, v106
    v_sub_f32 v106, v13, v14
    v_fmac_f32 v15, v106, v106
    v_xor_b32 v104, 4, v7
    ds_bpermute_b32 v105, v104, v15
    s_waitcnt lgkmcnt(0)
    v_add_f32 v15, v15, v105
    v_xor_b32 v104, 8, v7
    ds_bpermute_b32 v105, v104, v15
    s_waitcnt lgkmcnt(0)
    v_add_f32 v15, v15, v105
    v_xor_b32 v104, 16, v7
    ds_bpermute_b32 v105, v104, v15
    s_waitcnt lgkmcnt(0)
    v_add_f32 v15, v15, v105
    v_xor_b32 v104, 32, v7
    ds_bpermute_b32 v105, v104, v15
    s_waitcnt lgkmcnt(0)
    v_add_f32 v15, v15, v105
    v_xor_b32 v104, 64, v7
    ds_bpermute_b32 v105, v104, v15
    s_waitcnt lgkmcnt(0)
    v_add_f32 v15, v15, v105
    v_xor_b32 v104, 128, v7
    ds_bpermute_b32 v105, v104, v15
    s_waitcnt lgkmcnt(0)
    v_add_f32 v15, v15, v105
    v_lshrrev_b32 v104, 6, v0
    v_lshlrev_b32 v104, 2, v104
    ds_write_b32 v104, v15 offset:2064
    s_waitcnt lgkmcnt(0)
    s_barrier
    v_mov_b32 v104, 0
    ds_read_b128 v[108:111], v104 offset:2064
    s_waitcnt lgkmcnt(0)
    v_add_f32 v15, v108, v109
    v_add_f32 v15, v15, v110
    v_add_f32 v15, v15, v111
    v_mul_f32 v15, 0x3a800000, v15
    v_cvt_pk_bf16_f32 v104, v15, v15
    v_lshlrev_b32 v15, 16, v104
    v_add_f32 v15, 0x3727c5ac, v15
    v_cvt_pk_bf16_f32 v104, v15, v15
    v_lshlrev_b32 v15, 16, v104
    v_sqrt_f32 v15, v15
    s_nop 0
    v_cvt_pk_bf16_f32 v104, v15, v15
    v_lshlrev_b32 v15, 16, v104
    v_cvt_pk_bf16_f32 v104, v14, v14
    v_lshlrev_b32 v14, 16, v104
    v_cmp_gt_u32 vcc, 256, v0
    s_and_saveexec_b64 s[30:31], vcc
    s_cbranch_execz L_k5_x
    s_mul_i32 s28, s28, 1024
    v_lshlrev_b32 v8, 2, v0
    v_add_u32 v8, s28, v8
    ds_read_b32 v9, v8 offset:12288
    s_mov_b32 s24, 12288
    buffer_load_dword v112, v8, s[8:11], s24 offen sc0 sc1
    s_mov_b32 s24, 36864
    buffer_load_dword v113, v8, s[8:11], s24 offen sc0 sc1
    s_mov_b32 s24, 61440
    buffer_load_dword v114, v8, s[8:11], s24 offen sc0 sc1
    s_mov_b32 s24, 86016
    buffer_load_dword v115, v8, s[8:11], s24 offen sc0 sc1
    s_mov_b32 s24, 110592
    buffer_load_dword v116, v8, s[8:11], s24 offen sc0 sc1
    s_mov_b32 s24, 135168
    buffer_load_dword v117, v8, s[8:11], s24 offen sc0 sc1
    s_mov_b32 s24, 159744
    buffer_load_dword v118, v8, s[8:11], s24 offen sc0 sc1
    s_mov_b32 s24, 184320
    buffer_load_dword v119, v8, s[8:11], s24 offen sc0 sc1
    s_waitcnt vmcnt(0)
    v_mov_b32 v108, v112
    v_add_f32 v108, v108, v113
    v_add_f32 v108, v108, v114
    v_add_f32 v108, v108, v115
    v_add_f32 v108, v108, v116
    v_add_f32 v108, v108, v117
    v_add_f32 v108, v108, v118
    v_add_f32 v108, v108, v119
    s_mov_b32 s24, 16384
    buffer_load_dword v112, v8, s[8:11], s24 offen sc0 sc1
    s_mov_b32 s24, 40960
    buffer_load_dword v113, v8, s[8:11], s24 offen sc0 sc1
    s_mov_b32 s24, 65536
    buffer_load_dword v114, v8, s[8:11], s24 offen sc0 sc1
    s_mov_b32 s24, 90112
    buffer_load_dword v115, v8, s[8:11], s24 offen sc0 sc1
    s_mov_b32 s24, 114688
    buffer_load_dword v116, v8, s[8:11], s24 offen sc0 sc1
    s_mov_b32 s24, 139264
    buffer_load_dword v117, v8, s[8:11], s24 offen sc0 sc1
    s_mov_b32 s24, 163840
    buffer_load_dword v118, v8, s[8:11], s24 offen sc0 sc1
    s_mov_b32 s24, 188416
    buffer_load_dword v119, v8, s[8:11], s24 offen sc0 sc1
    s_waitcnt vmcnt(0)
    v_mov_b32 v109, v112
    v_add_f32 v109, v109, v113
    v_add_f32 v109, v109, v114
    v_add_f32 v109, v109, v115
    v_add_f32 v109, v109, v116
    v_add_f32 v109, v109, v117
    v_add_f32 v109, v109, v118
    v_add_f32 v109, v109, v119
    v_cvt_pk_bf16_f32 v104, v108, v108
    v_lshlrev_b32 v108, 16, v104
    v_cvt_pk_bf16_f32 v104, v109, v109
    v_lshlrev_b32 v109, 16, v104
    s_waitcnt lgkmcnt(0)
    v_sub_f32 v9, v9, v14
    v_cvt_pk_bf16_f32 v104, v9, v9
    v_lshlrev_b32 v9, 16, v104
    v_rcp_f32 v105, v15
    s_nop 0
    v_mul_f32 v106, v9, v105
    v_fma_f32 v107, -v106, v15, v9
    v_fma_f32 v9, v107, v105, v106
    v_cvt_pk_bf16_f32 v104, v9, v9
    v_lshlrev_b32 v9, 16, v104
    v_add_f32 v109, 1.0, v109
    v_cvt_pk_bf16_f32 v104, v109, v109
    v_lshlrev_b32 v109, 16, v104
    v_mul_f32 v9, v9, v109
    v_cvt_pk_bf16_f32 v104, v9, v9
    v_lshlrev_b32 v9, 16, v104
    v_add_f32 v9, v9, v108
    v_cvt_pk_bf16_f32 v104, v9, v9
    v_lshlrev_b32 v9, 16, v104
    v_lshlrev_b32 v8, 2, v0
    ds_write_b32 v8, v9
L_k5_x:
    s_mov_b64 exec, s[30:31]
    s_waitcnt lgkmcnt(0)
    s_barrier
    v_lshlrev_b32 v4, 2, v1
    ds_read_b32 v80, v4 offset:0
    ds_read_b32 v81, v4 offset:64
    ds_read_b32 v82, v4 offset:128
    ds_read_b32 v83, v4 offset:192
    ds_read_b32 v84, v4 offset:256
    ds_read_b32 v85, v4 offset:320
    ds_read_b32 v86, v4 offset:384
    ds_read_b32 v87, v4 offset:448
    ds_read_b32 v88, v4 offset:512
    ds_read_b32 v89, v4 offset:576
    ds_read_b32 v90, v4 offset:640
    ds_read_b32 v91, v4 offset:704
    ds_read_b32 v92, v4 offset:768
    ds_read_b32 v93, v4 offset:832
    ds_read_b32 v94, v4 offset:896
    ds_read_b32 v95, v4 offset:960
    v_mov_b32 v96, 0
    v_mov_b32 v97, 0
    v_mov_b32 v98, 0
    v_mov_b32 v99, 0
    v_mov_b32 v100, 0
    v_mov_b32 v101, 0
    v_mov_b32 v102, 0
    v_mov_b32 v103, 0
    s_waitcnt lgkmcnt(0)
    s_waitcnt vmcnt(15)
    v_lshlrev_b32 v5, 16, v16
    v_and_b32 v6, 0xffff0000, v16
    v_fmac_f32 v96, v5, v80
    v_fmac_f32 v97, v6, v80
    v_lshlrev_b32 v5, 16, v17
    v_and_b32 v6, 0xffff0000, v17
    v_fmac_f32 v98, v5, v80
    v_fmac_f32 v99, v6, v80
    v_lshlrev_b32 v5, 16, v18
    v_and_b32 v6, 0xffff0000, v18
    v_fmac_f32 v100, v5, v80
    v_fmac_f32 v101, v6, v80
    v_lshlrev_b32 v5, 16, v19
    v_and_b32 v6, 0xffff0000, v19
    v_fmac_f32 v102, v5, v80
    v_fmac_f32 v103, v6, v80
    s_waitcnt vmcnt(14)
    v_lshlrev_b32 v5, 16, v20
    v_and_b32 v6, 0xffff0000, v20
    v_fmac_f32 v96, v5, v81
    v_fmac_f32 v97, v6, v81
    v_lshlrev_b32 v5, 16, v21
    v_and_b32 v6, 0xffff0000, v21
    v_fmac_f32 v98, v5, v81
    v_fmac_f32 v99, v6, v81
    v_lshlrev_b32 v5, 16, v22
    v_and_b32 v6, 0xffff0000, v22
    v_fmac_f32 v100, v5, v81
    v_fmac_f32 v101, v6, v81
    v_lshlrev_b32 v5, 16, v23
    v_and_b32 v6, 0xffff0000, v23
    v_fmac_f32 v102, v5, v81
    v_fmac_f32 v103, v6, v81
    s_waitcnt vmcnt(13)
    v_lshlrev_b32 v5, 16, v24
    v_and_b32 v6, 0xffff0000, v24
    v_fmac_f32 v96, v5, v82
    v_fmac_f32 v97, v6, v82
    v_lshlrev_b32 v5, 16, v25
    v_and_b32 v6, 0xffff0000, v25
    v_fmac_f32 v98, v5, v82
    v_fmac_f32 v99, v6, v82
    v_lshlrev_b32 v5, 16, v26
    v_and_b32 v6, 0xffff0000, v26
    v_fmac_f32 v100, v5, v82
    v_fmac_f32 v101, v6, v82
    v_lshlrev_b32 v5, 16, v27
    v_and_b32 v6, 0xffff0000, v27
    v_fmac_f32 v102, v5, v82
    v_fmac_f32 v103, v6, v82
    s_waitcnt vmcnt(12)
    v_lshlrev_b32 v5, 16, v28
    v_and_b32 v6, 0xffff0000, v28
    v_fmac_f32 v96, v5, v83
    v_fmac_f32 v97, v6, v83
    v_lshlrev_b32 v5, 16, v29
    v_and_b32 v6, 0xffff0000, v29
    v_fmac_f32 v98, v5, v83
    v_fmac_f32 v99, v6, v83
    v_lshlrev_b32 v5, 16, v30
    v_and_b32 v6, 0xffff0000, v30
    v_fmac_f32 v100, v5, v83
    v_fmac_f32 v101, v6, v83
    v_lshlrev_b32 v5, 16, v31
    v_and_b32 v6, 0xffff0000, v31
    v_fmac_f32 v102, v5, v83
    v_fmac_f32 v103, v6, v83
    s_waitcnt vmcnt(11)
    v_lshlrev_b32 v5, 16, v32
    v_and_b32 v6, 0xffff0000, v32
    v_fmac_f32 v96, v5, v84
    v_fmac_f32 v97, v6, v84
    v_lshlrev_b32 v5, 16, v33
    v_and_b32 v6, 0xffff0000, v33
    v_fmac_f32 v98, v5, v84
    v_fmac_f32 v99, v6, v84
    v_lshlrev_b32 v5, 16, v34
    v_and_b32 v6, 0xffff0000, v34
    v_fmac_f32 v100, v5, v84
    v_fmac_f32 v101, v6, v84
    v_lshlrev_b32 v5, 16, v35
    v_and_b32 v6, 0xffff0000, v35
    v_fmac_f32 v102, v5, v84
    v_fmac_f32 v103, v6, v84
    s_waitcnt vmcnt(10)
    v_lshlrev_b32 v5, 16, v36
    v_and_b32 v6, 0xffff0000, v36
    v_fmac_f32 v96, v5, v85
    v_fmac_f32 v97, v6, v85
    v_lshlrev_b32 v5, 16, v37
    v_and_b32 v6, 0xffff0000, v37
    v_fmac_f32 v98, v5, v85
    v_fmac_f32 v99, v6, v85
    v_lshlrev_b32 v5, 16, v38
    v_and_b32 v6, 0xffff0000, v38
    v_fmac_f32 v100, v5, v85
    v_fmac_f32 v101, v6, v85
    v_lshlrev_b32 v5, 16, v39
    v_and_b32 v6, 0xffff0000, v39
    v_fmac_f32 v102, v5, v85
    v_fmac_f32 v103, v6, v85
    s_waitcnt vmcnt(9)
    v_lshlrev_b32 v5, 16, v40
    v_and_b32 v6, 0xffff0000, v40
    v_fmac_f32 v96, v5, v86
    v_fmac_f32 v97, v6, v86
    v_lshlrev_b32 v5, 16, v41
    v_and_b32 v6, 0xffff0000, v41
    v_fmac_f32 v98, v5, v86
    v_fmac_f32 v99, v6, v86
    v_lshlrev_b32 v5, 16, v42
    v_and_b32 v6, 0xffff0000, v42
    v_fmac_f32 v100, v5, v86
    v_fmac_f32 v101, v6, v86
    v_lshlrev_b32 v5, 16, v43
    v_and_b32 v6, 0xffff0000, v43
    v_fmac_f32 v102, v5, v86
    v_fmac_f32 v103, v6, v86
    s_waitcnt vmcnt(8)
    v_lshlrev_b32 v5, 16, v44
    v_and_b32 v6, 0xffff0000, v44
    v_fmac_f32 v96, v5, v87
    v_fmac_f32 v97, v6, v87
    v_lshlrev_b32 v5, 16, v45
    v_and_b32 v6, 0xffff0000, v45
    v_fmac_f32 v98, v5, v87
    v_fmac_f32 v99, v6, v87
    v_lshlrev_b32 v5, 16, v46
    v_and_b32 v6, 0xffff0000, v46
    v_fmac_f32 v100, v5, v87
    v_fmac_f32 v101, v6, v87
    v_lshlrev_b32 v5, 16, v47
    v_and_b32 v6, 0xffff0000, v47
    v_fmac_f32 v102, v5, v87
    v_fmac_f32 v103, v6, v87
    s_waitcnt vmcnt(7)
    v_lshlrev_b32 v5, 16, v48
    v_and_b32 v6, 0xffff0000, v48
    v_fmac_f32 v96, v5, v88
    v_fmac_f32 v97, v6, v88
    v_lshlrev_b32 v5, 16, v49
    v_and_b32 v6, 0xffff0000, v49
    v_fmac_f32 v98, v5, v88
    v_fmac_f32 v99, v6, v88
    v_lshlrev_b32 v5, 16, v50
    v_and_b32 v6, 0xffff0000, v50
    v_fmac_f32 v100, v5, v88
    v_fmac_f32 v101, v6, v88
    v_lshlrev_b32 v5, 16, v51
    v_and_b32 v6, 0xffff0000, v51
    v_fmac_f32 v102, v5, v88
    v_fmac_f32 v103, v6, v88
    s_waitcnt vmcnt(6)
    v_lshlrev_b32 v5, 16, v52
    v_and_b32 v6, 0xffff0000, v52
    v_fmac_f32 v96, v5, v89
    v_fmac_f32 v97, v6, v89
    v_lshlrev_b32 v5, 16, v53
    v_and_b32 v6, 0xffff0000, v53
    v_fmac_f32 v98, v5, v89
    v_fmac_f32 v99, v6, v89
    v_lshlrev_b32 v5, 16, v54
    v_and_b32 v6, 0xffff0000, v54
    v_fmac_f32 v100, v5, v89
    v_fmac_f32 v101, v6, v89
    v_lshlrev_b32 v5, 16, v55
    v_and_b32 v6, 0xffff0000, v55
    v_fmac_f32 v102, v5, v89
    v_fmac_f32 v103, v6, v89
    s_waitcnt vmcnt(5)
    v_lshlrev_b32 v5, 16, v56
    v_and_b32 v6, 0xffff0000, v56
    v_fmac_f32 v96, v5, v90
    v_fmac_f32 v97, v6, v90
    v_lshlrev_b32 v5, 16, v57
    v_and_b32 v6, 0xffff0000, v57
    v_fmac_f32 v98, v5, v90
    v_fmac_f32 v99, v6, v90
    v_lshlrev_b32 v5, 16, v58
    v_and_b32 v6, 0xffff0000, v58
    v_fmac_f32 v100, v5, v90
    v_fmac_f32 v101, v6, v90
    v_lshlrev_b32 v5, 16, v59
    v_and_b32 v6, 0xffff0000, v59
    v_fmac_f32 v102, v5, v90
    v_fmac_f32 v103, v6, v90
    s_waitcnt vmcnt(4)
    v_lshlrev_b32 v5, 16, v60
    v_and_b32 v6, 0xffff0000, v60
    v_fmac_f32 v96, v5, v91
    v_fmac_f32 v97, v6, v91
    v_lshlrev_b32 v5, 16, v61
    v_and_b32 v6, 0xffff0000, v61
    v_fmac_f32 v98, v5, v91
    v_fmac_f32 v99, v6, v91
    v_lshlrev_b32 v5, 16, v62
    v_and_b32 v6, 0xffff0000, v62
    v_fmac_f32 v100, v5, v91
    v_fmac_f32 v101, v6, v91
    v_lshlrev_b32 v5, 16, v63
    v_and_b32 v6, 0xffff0000, v63
    v_fmac_f32 v102, v5, v91
    v_fmac_f32 v103, v6, v91
    s_waitcnt vmcnt(3)
    v_lshlrev_b32 v5, 16, v64
    v_and_b32 v6, 0xffff0000, v64
    v_fmac_f32 v96, v5, v92
    v_fmac_f32 v97, v6, v92
    v_lshlrev_b32 v5, 16, v65
    v_and_b32 v6, 0xffff0000, v65
    v_fmac_f32 v98, v5, v92
    v_fmac_f32 v99, v6, v92
    v_lshlrev_b32 v5, 16, v66
    v_and_b32 v6, 0xffff0000, v66
    v_fmac_f32 v100, v5, v92
    v_fmac_f32 v101, v6, v92
    v_lshlrev_b32 v5, 16, v67
    v_and_b32 v6, 0xffff0000, v67
    v_fmac_f32 v102, v5, v92
    v_fmac_f32 v103, v6, v92
    s_waitcnt vmcnt(2)
    v_lshlrev_b32 v5, 16, v68
    v_and_b32 v6, 0xffff0000, v68
    v_fmac_f32 v96, v5, v93
    v_fmac_f32 v97, v6, v93
    v_lshlrev_b32 v5, 16, v69
    v_and_b32 v6, 0xffff0000, v69
    v_fmac_f32 v98, v5, v93
    v_fmac_f32 v99, v6, v93
    v_lshlrev_b32 v5, 16, v70
    v_and_b32 v6, 0xffff0000, v70
    v_fmac_f32 v100, v5, v93
    v_fmac_f32 v101, v6, v93
    v_lshlrev_b32 v5, 16, v71
    v_and_b32 v6, 0xffff0000, v71
    v_fmac_f32 v102, v5, v93
    v_fmac_f32 v103, v6, v93
    s_waitcnt vmcnt(1)
    v_lshlrev_b32 v5, 16, v72
    v_and_b32 v6, 0xffff0000, v72
    v_fmac_f32 v96, v5, v94
    v_fmac_f32 v97, v6, v94
    v_lshlrev_b32 v5, 16, v73
    v_and_b32 v6, 0xffff0000, v73
    v_fmac_f32 v98, v5, v94
    v_fmac_f32 v99, v6, v94
    v_lshlrev_b32 v5, 16, v74
    v_and_b32 v6, 0xffff0000, v74
    v_fmac_f32 v100, v5, v94
    v_fmac_f32 v101, v6, v94
    v_lshlrev_b32 v5, 16, v75
    v_and_b32 v6, 0xffff0000, v75
    v_fmac_f32 v102, v5, v94
    v_fmac_f32 v103, v6, v94
    s_waitcnt vmcnt(0)
    v_lshlrev_b32 v5, 16, v76
    v_and_b32 v6, 0xffff0000, v76
    v_fmac_f32 v96, v5, v95
    v_fmac_f32 v97, v6, v95
    v_lshlrev_b32 v5, 16, v77
    v_and_b32 v6, 0xffff0000, v77
    v_fmac_f32 v98, v5, v95
    v_fmac_f32 v99, v6, v95
    v_lshlrev_b32 v5, 16, v78
    v_and_b32 v6, 0xffff0000, v78
    v_fmac_f32 v100, v5, v95
    v_fmac_f32 v101, v6, v95
    v_lshlrev_b32 v5, 16, v79
    v_and_b32 v6, 0xffff0000, v79
    v_fmac_f32 v102, v5, v95
    v_fmac_f32 v103, v6, v95
    v_lshlrev_b32 v4, 9, v1
    v_lshl_add_u32 v4, v2, 5, v4
    ds_write_b128 v4, v[96:99] offset:4096
    ds_write_b128 v4, v[100:103] offset:4112
    s_waitcnt lgkmcnt(0)
    s_barrier
    v_cmp_gt_u32 vcc, 128, v0
    s_and_saveexec_b64 s[30:31], vcc
    s_cbranch_execz L_3967
    v_lshlrev_b32 v4, 2, v0
    ds_read_b32 v16, v4 offset:4096
    ds_read_b32 v17, v4 offset:4608
    ds_read_b32 v18, v4 offset:5120
    ds_read_b32 v19, v4 offset:5632
    ds_read_b32 v20, v4 offset:6144
    ds_read_b32 v21, v4 offset:6656
    ds_read_b32 v22, v4 offset:7168
    ds_read_b32 v23, v4 offset:7680
    ds_read_b32 v24, v4 offset:8192
    ds_read_b32 v25, v4 offset:8704
    ds_read_b32 v26, v4 offset:9216
    ds_read_b32 v27, v4 offset:9728
    ds_read_b32 v28, v4 offset:10240
    ds_read_b32 v29, v4 offset:10752
    ds_read_b32 v30, v4 offset:11264
    ds_read_b32 v31, v4 offset:11776
    s_waitcnt lgkmcnt(0)
    v_add_f32 v16, v16, v17
    v_add_f32 v16, v16, v18
    v_add_f32 v16, v16, v19
    v_add_f32 v16, v16, v20
    v_add_f32 v16, v16, v21
    v_add_f32 v16, v16, v22
    v_add_f32 v16, v16, v23
    v_add_f32 v16, v16, v24
    v_add_f32 v16, v16, v25
    v_add_f32 v16, v16, v26
    v_add_f32 v16, v16, v27
    v_add_f32 v16, v16, v28
    v_add_f32 v16, v16, v29
    v_add_f32 v16, v16, v30
    v_add_f32 v16, v16, v31
    buffer_store_dword v16, v4, s[8:11], s21 offen sc0 sc1
L_3967:
    s_mov_b64 exec, s[30:31]
L_end_4:
    s_endpgm
.p2align 8
.globl k6_down_kernel
.type k6_down_kernel,@function
k6_down_kernel:
    s_cmp_ge_u32 s2, 224
    s_cbranch_scc1 L_end_5
    s_load_dwordx2 s[12:13], s[0:1], 64
    s_load_dwordx2 s[14:15], s[0:1], 104
    s_load_dwordx2 s[16:17], s[0:1], 96
    s_load_dwordx2 s[18:19], s[0:1], 88
    s_waitcnt lgkmcnt(0)
    s_mov_b32 s4, s12
    s_and_b32 s5, s13, 0xffff
    s_mov_b32 s6, 7340032
    s_mov_b32 s7, 0x00020000
    s_mov_b32 s8, s14
    s_and_b32 s9, s15, 0xffff
    s_mov_b32 s10, 268435456
    s_mov_b32 s11, 0x00020000
    s_mov_b32 s12, s16
    s_and_b32 s13, s17, 0xffff
    s_mov_b32 s14, 256
    s_mov_b32 s15, 0x00020000
    s_mov_b32 s16, s18
    s_and_b32 s17, s19, 0xffff
    s_mov_b32 s18, 2048
    s_mov_b32 s19, 0x00020000
    s_lshr_b32 s25, s2, 3
    s_and_b32 s26, s2, 7
    s_mul_i32 s20, s25, 262144
    s_lshl_b32 s27, s26, 8
    s_add_u32 s20, s20, s27
    s_lshl_b32 s21, s25, 12
    s_lshl_b32 s27, s26, 9
    s_add_u32 s21, s21, s27
    s_add_u32 s21, s21, 1638400
    v_lshrrev_b32 v1, 4, v0
    v_and_b32 v2, 15, v0
    s_mov_b32 s22, 2048
    v_mul_lo_u32 v3, v1, s22
    v_lshl_add_u32 v3, v2, 4, v3
    s_mov_b32 s23, s20
    buffer_load_dwordx4 v[16:19], v3, s[4:7], s23 offen nt
    s_add_u32 s23, s23, 32768
    buffer_load_dwordx4 v[20:23], v3, s[4:7], s23 offen nt
    s_add_u32 s23, s23, 32768
    buffer_load_dwordx4 v[24:27], v3, s[4:7], s23 offen nt
    s_add_u32 s23, s23, 32768
    buffer_load_dwordx4 v[28:31], v3, s[4:7], s23 offen nt
    s_add_u32 s23, s23, 32768
    buffer_load_dwordx4 v[32:35], v3, s[4:7], s23 offen nt
    s_add_u32 s23, s23, 32768
    buffer_load_dwordx4 v[36:39], v3, s[4:7], s23 offen nt
    s_add_u32 s23, s23, 32768
    buffer_load_dwordx4 v[40:43], v3, s[4:7], s23 offen nt
    s_add_u32 s23, s23, 32768
    buffer_load_dwordx4 v[44:47], v3, s[4:7], s23 offen nt
    v_cmp_gt_u32 vcc, 128, v0
    s_and_saveexec_b64 s[30:31], vcc
    s_cbranch_execz L_k6_x
    s_lshl_b32 s28, s25, 9
    v_lshlrev_b32 v8, 2, v0
    v_add_u32 v8, s28, v8
    s_mov_b32 s24, 1523712
    buffer_load_dword v60, v8, s[8:11], s24 offen sc0 sc1
    s_mov_b32 s24, 1538048
    buffer_load_dword v61, v8, s[8:11], s24 offen sc0 sc1
    s_mov_b32 s24, 1552384
    buffer_load_dword v62, v8, s[8:11], s24 offen sc0 sc1
    s_mov_b32 s24, 1566720
    buffer_load_dword v63, v8, s[8:11], s24 offen sc0 sc1
    s_waitcnt vmcnt(0)
    v_mov_b32 v104, v60
    v_add_f32 v104, v104, v61
    v_add_f32 v104, v104, v62
    v_add_f32 v104, v104, v63
    s_mov_b32 s24, 1581056
    buffer_load_dword v60, v8, s[8:11], s24 offen sc0 sc1
    s_mov_b32 s24, 1595392
    buffer_load_dword v61, v8, s[8:11], s24 offen sc0 sc1
    s_mov_b32 s24, 1609728
    buffer_load_dword v62, v8, s[8:11], s24 offen sc0 sc1
    s_mov_b32 s24, 1624064
    buffer_load_dword v63, v8, s[8:11], s24 offen sc0 sc1
    s_waitcnt vmcnt(0)
    v_mov_b32 v105, v60
    v_add_f32 v105, v105, v61
    v_add_f32 v105, v105, v62
    v_add_f32 v105, v105, v63
    v_cvt_pk_bf16_f32 v100, v104, v104
    v_lshlrev_b32 v104, 16, v100
    v_cvt_pk_bf16_f32 v100, v105, v105
    v_lshlrev_b32 v105, 16, v100
    v_mul_f32 v100, v104, v104
    v_mul_f32 v100, 0x3d372713, v100
    v_add_f32 v100, 1.0, v100
    v_mul_f32 v100, v100, v104
    v_mul_f32 v100, 0x40135761, v100
    v_exp_f32 v100, v100
    s_nop 0
    v_add_f32 v100, 1.0, v100
    v_rcp_f32 v100, v100
    s_nop 0
    v_sub_f32 v100, 1.0, v100
    v_mul_f32 v104, v104, v100
    v_cvt_pk_bf16_f32 v100, v104, v104
    v_lshlrev_b32 v104, 16, v100
    v_mul_f32 v104, v104, v105
    v_cvt_pk_bf16_f32 v100, v104, v104
    v_lshlrev_b32 v104, 16, v100
    v_lshlrev_b32 v8, 2, v0
    ds_write_b32 v8, v104
L_k6_x:
    s_mov_b64 exec, s[30:31]
    s_waitcnt lgkmcnt(0)
    s_barrier
    v_lshlrev_b32 v4, 2, v1
    ds_read_b32 v48, v4 offset:0
    ds_read_b32 v49, v4 offset:64
    ds_read_b32 v50, v4 offset:128
    ds_read_b32 v51, v4 offset:192
    ds_read_b32 v52, v4 offset:256
    ds_read_b32 v53, v4 offset:320
    ds_read_b32 v54, v4 offset:384
    ds_read_b32 v55, v4 offset:448
    v_mov_b32 v56, 0
    v_mov_b32 v57, 0
    v_mov_b32 v58, 0
    v_mov_b32 v59, 0
    v_mov_b32 v60, 0
    v_mov_b32 v61, 0
    v_mov_b32 v62, 0
    v_mov_b32 v63, 0
    s_waitcnt lgkmcnt(0)
    s_waitcnt vmcnt(7)
    v_lshlrev_b32 v5, 16, v16
    v_and_b32 v6, 0xffff0000, v16
    v_fmac_f32 v56, v5, v48
    v_fmac_f32 v57, v6, v48
    v_lshlrev_b32 v5, 16, v17
    v_and_b32 v6, 0xffff0000, v17
    v_fmac_f32 v58, v5, v48
    v_fmac_f32 v59, v6, v48
    v_lshlrev_b32 v5, 16, v18
    v_and_b32 v6, 0xffff0000, v18
    v_fmac_f32 v60, v5, v48
    v_fmac_f32 v61, v6, v48
    v_lshlrev_b32 v5, 16, v19
    v_and_b32 v6, 0xffff0000, v19
    v_fmac_f32 v62, v5, v48
    v_fmac_f32 v63, v6, v48
    s_waitcnt vmcnt(6)
    v_lshlrev_b32 v5, 16, v20
    v_and_b32 v6, 0xffff0000, v20
    v_fmac_f32 v56, v5, v49
    v_fmac_f32 v57, v6, v49
    v_lshlrev_b32 v5, 16, v21
    v_and_b32 v6, 0xffff0000, v21
    v_fmac_f32 v58, v5, v49
    v_fmac_f32 v59, v6, v49
    v_lshlrev_b32 v5, 16, v22
    v_and_b32 v6, 0xffff0000, v22
    v_fmac_f32 v60, v5, v49
    v_fmac_f32 v61, v6, v49
    v_lshlrev_b32 v5, 16, v23
    v_and_b32 v6, 0xffff0000, v23
    v_fmac_f32 v62, v5, v49
    v_fmac_f32 v63, v6, v49
    s_waitcnt vmcnt(5)
    v_lshlrev_b32 v5, 16, v24
    v_and_b32 v6, 0xffff0000, v24
    v_fmac_f32 v56, v5, v50
    v_fmac_f32 v57, v6, v50
    v_lshlrev_b32 v5, 16, v25
    v_and_b32 v6, 0xffff0000, v25
    v_fmac_f32 v58, v5, v50
    v_fmac_f32 v59, v6, v50
    v_lshlrev_b32 v5, 16, v26
    v_and_b32 v6, 0xffff0000, v26
    v_fmac_f32 v60, v5, v50
    v_fmac_f32 v61, v6, v50
    v_lshlrev_b32 v5, 16, v27
    v_and_b32 v6, 0xffff0000, v27
    v_fmac_f32 v62, v5, v50
    v_fmac_f32 v63, v6, v50
    s_waitcnt vmcnt(4)
    v_lshlrev_b32 v5, 16, v28
    v_and_b32 v6, 0xffff0000, v28
    v_fmac_f32 v56, v5, v51
    v_fmac_f32 v57, v6, v51
    v_lshlrev_b32 v5, 16, v29
    v_and_b32 v6, 0xffff0000, v29
    v_fmac_f32 v58, v5, v51
    v_fmac_f32 v59, v6, v51
    v_lshlrev_b32 v5, 16, v30
    v_and_b32 v6, 0xffff0000, v30
    v_fmac_f32 v60, v5, v51
    v_fmac_f32 v61, v6, v51
    v_lshlrev_b32 v5, 16, v31
    v_and_b32 v6, 0xffff0000, v31
    v_fmac_f32 v62, v5, v51
    v_fmac_f32 v63, v6, v51
    s_waitcnt vmcnt(3)
    v_lshlrev_b32 v5, 16, v32
    v_and_b32 v6, 0xffff0000, v32
    v_fmac_f32 v56, v5, v52
    v_fmac_f32 v57, v6, v52
    v_lshlrev_b32 v5, 16, v33
    v_and_b32 v6, 0xffff0000, v33
    v_fmac_f32 v58, v5, v52
    v_fmac_f32 v59, v6, v52
    v_lshlrev_b32 v5, 16, v34
    v_and_b32 v6, 0xffff0000, v34
    v_fmac_f32 v60, v5, v52
    v_fmac_f32 v61, v6, v52
    v_lshlrev_b32 v5, 16, v35
    v_and_b32 v6, 0xffff0000, v35
    v_fmac_f32 v62, v5, v52
    v_fmac_f32 v63, v6, v52
    s_waitcnt vmcnt(2)
    v_lshlrev_b32 v5, 16, v36
    v_and_b32 v6, 0xffff0000, v36
    v_fmac_f32 v56, v5, v53
    v_fmac_f32 v57, v6, v53
    v_lshlrev_b32 v5, 16, v37
    v_and_b32 v6, 0xffff0000, v37
    v_fmac_f32 v58, v5, v53
    v_fmac_f32 v59, v6, v53
    v_lshlrev_b32 v5, 16, v38
    v_and_b32 v6, 0xffff0000, v38
    v_fmac_f32 v60, v5, v53
    v_fmac_f32 v61, v6, v53
    v_lshlrev_b32 v5, 16, v39
    v_and_b32 v6, 0xffff0000, v39
    v_fmac_f32 v62, v5, v53
    v_fmac_f32 v63, v6, v53
    s_waitcnt vmcnt(1)
    v_lshlrev_b32 v5, 16, v40
    v_and_b32 v6, 0xffff0000, v40
    v_fmac_f32 v56, v5, v54
    v_fmac_f32 v57, v6, v54
    v_lshlrev_b32 v5, 16, v41
    v_and_b32 v6, 0xffff0000, v41
    v_fmac_f32 v58, v5, v54
    v_fmac_f32 v59, v6, v54
    v_lshlrev_b32 v5, 16, v42
    v_and_b32 v6, 0xffff0000, v42
    v_fmac_f32 v60, v5, v54
    v_fmac_f32 v61, v6, v54
    v_lshlrev_b32 v5, 16, v43
    v_and_b32 v6, 0xffff0000, v43
    v_fmac_f32 v62, v5, v54
    v_fmac_f32 v63, v6, v54
    s_waitcnt vmcnt(0)
    v_lshlrev_b32 v5, 16, v44
    v_and_b32 v6, 0xffff0000, v44
    v_fmac_f32 v56, v5, v55
    v_fmac_f32 v57, v6, v55
    v_lshlrev_b32 v5, 16, v45
    v_and_b32 v6, 0xffff0000, v45
    v_fmac_f32 v58, v5, v55
    v_fmac_f32 v59, v6, v55
    v_lshlrev_b32 v5, 16, v46
    v_and_b32 v6, 0xffff0000, v46
    v_fmac_f32 v60, v5, v55
    v_fmac_f32 v61, v6, v55
    v_lshlrev_b32 v5, 16, v47
    v_and_b32 v6, 0xffff0000, v47
    v_fmac_f32 v62, v5, v55
    v_fmac_f32 v63, v6, v55
    v_lshlrev_b32 v4, 9, v1
    v_lshl_add_u32 v4, v2, 5, v4
    ds_write_b128 v4, v[56:59] offset:4096
    ds_write_b128 v4, v[60:63] offset:4112
    s_waitcnt lgkmcnt(0)
    s_barrier
    v_cmp_gt_u32 vcc, 128, v0
    s_and_saveexec_b64 s[30:31], vcc
    s_cbranch_execz L_4284
    v_lshlrev_b32 v4, 2, v0
    ds_read_b32 v16, v4 offset:4096
    ds_read_b32 v17, v4 offset:4608
    ds_read_b32 v18, v4 offset:5120
    ds_read_b32 v19, v4 offset:5632
    ds_read_b32 v20, v4 offset:6144
    ds_read_b32 v21, v4 offset:6656
    ds_read_b32 v22, v4 offset:7168
    ds_read_b32 v23, v4 offset:7680
    ds_read_b32 v24, v4 offset:8192
    ds_read_b32 v25, v4 offset:8704
    ds_read_b32 v26, v4 offset:9216
    ds_read_b32 v27, v4 offset:9728
    ds_read_b32 v28, v4 offset:10240
    ds_read_b32 v29, v4 offset:10752
    ds_read_b32 v30, v4 offset:11264
    ds_read_b32 v31, v4 offset:11776
    s_waitcnt lgkmcnt(0)
    v_add_f32 v16, v16, v17
    v_add_f32 v16, v16, v18
    v_add_f32 v16, v16, v19
    v_add_f32 v16, v16, v20
    v_add_f32 v16, v16, v21
    v_add_f32 v16, v16, v22
    v_add_f32 v16, v16, v23
    v_add_f32 v16, v16, v24
    v_add_f32 v16, v16, v25
    v_add_f32 v16, v16, v26
    v_add_f32 v16, v16, v27
    v_add_f32 v16, v16, v28
    v_add_f32 v16, v16, v29
    v_add_f32 v16, v16, v30
    v_add_f32 v16, v16, v31
    buffer_store_dword v16, v4, s[8:11], s21 offen sc0 sc1
L_4284:
    s_mov_b64 exec, s[30:31]
    s_waitcnt vmcnt(0)
    s_barrier
    v_mov_b32 v20, 1
    v_mov_b32 v21, 0
    v_cmp_eq_u32 vcc, 0, v0
    s_and_saveexec_b64 s[30:31], vcc
    buffer_atomic_add v20, v21, s[12:15], 0 offen sc0 sc1
    s_waitcnt vmcnt(0)
    ds_write_b32 v21, v20 offset:2048
    s_mov_b64 exec, s[30:31]
    s_waitcnt lgkmcnt(0)
    s_barrier
    ds_read_b32 v20, v21 offset:2048
    s_waitcnt lgkmcnt(0)
    v_readfirstlane_b32 s24, v20
    s_cmp_lg_u32 s24, 223
    s_cbranch_scc1 L_end_5
    v_lshlrev_b32 v8, 4, v0
    s_mov_b32 s24, 1638400
    buffer_load_dwordx4 v[60:63], v8, s[8:11], s24 offen sc0 sc1
    s_mov_b32 s24, 1642496
    buffer_load_dwordx4 v[64:67], v8, s[8:11], s24 offen sc0 sc1
    s_mov_b32 s24, 1646592
    buffer_load_dwordx4 v[68:71], v8, s[8:11], s24 offen sc0 sc1
    s_mov_b32 s24, 1650688
    buffer_load_dwordx4 v[72:75], v8, s[8:11], s24 offen sc0 sc1
    s_mov_b32 s24, 1654784
    buffer_load_dwordx4 v[76:79], v8, s[8:11], s24 offen sc0 sc1
    s_mov_b32 s24, 1658880
    buffer_load_dwordx4 v[80:83], v8, s[8:11], s24 offen sc0 sc1
    s_mov_b32 s24, 1662976
    buffer_load_dwordx4 v[84:87], v8, s[8:11], s24 offen sc0 sc1
    s_mov_b32 s24, 1667072
    buffer_load_dwordx4 v[88:91], v8, s[8:11], s24 offen sc0 sc1
    s_mov_b32 s24, 1671168
    buffer_load_dwordx4 v[92:95], v8, s[8:11], s24 offen sc0 sc1
    s_mov_b32 s24, 1675264
    buffer_load_dwordx4 v[96:99], v8, s[8:11], s24 offen sc0 sc1
    s_mov_b32 s24, 1679360
    buffer_load_dwordx4 v[100:103], v8, s[8:11], s24 offen sc0 sc1
    s_mov_b32 s24, 1683456
    buffer_load_dwordx4 v[104:107], v8, s[8:11], s24 offen sc0 sc1
    s_mov_b32 s24, 1687552
    buffer_load_dwordx4 v[108:111], v8, s[8:11], s24 offen sc0 sc1
    s_mov_b32 s24, 1691648
    buffer_load_dwordx4 v[112:115], v8, s[8:11], s24 offen sc0 sc1
    s_mov_b32 s24, 1695744
    buffer_load_dwordx4 v[116:119], v8, s[8:11], s24 offen sc0 sc1
    s_mov_b32 s24, 1699840
    buffer_load_dwordx4 v[120:123], v8, s[8:11], s24 offen sc0 sc1
    s_mov_b32 s24, 1703936
    buffer_load_dwordx4 v[124:127], v8, s[8:11], s24 offen sc0 sc1
    s_mov_b32 s24, 1708032
    buffer_load_dwordx4 v[128:131], v8, s[8:11], s24 offen sc0 sc1
    s_mov_b32 s24, 1712128
    buffer_load_dwordx4 v[132:135], v8, s[8:11], s24 offen sc0 sc1
    s_mov_b32 s24, 1716224
    buffer_load_dwordx4 v[136:139], v8, s[8:11], s24 offen sc0 sc1
    s_mov_b32 s24, 1720320
    buffer_load_dwordx4 v[140:143], v8, s[8:11], s24 offen sc0 sc1
    s_mov_b32 s24, 1724416
    buffer_load_dwordx4 v[144:147], v8, s[8:11], s24 offen sc0 sc1
    s_mov_b32 s24, 1728512
    buffer_load_dwordx4 v[148:151], v8, s[8:11], s24 offen sc0 sc1
    s_mov_b32 s24, 1732608
    buffer_load_dwordx4 v[152:155], v8, s[8:11], s24 offen sc0 sc1
    s_mov_b32 s24, 1736704
    buffer_load_dwordx4 v[156:159], v8, s[8:11], s24 offen sc0 sc1
    s_mov_b32 s24, 1740800
    buffer_load_dwordx4 v[160:163], v8, s[8:11], s24 offen sc0 sc1
    s_mov_b32 s24, 1744896
    buffer_load_dwordx4 v[164:167], v8, s[8:11], s24 offen sc0 sc1
    s_mov_b32 s24, 1748992
    buffer_load_dwordx4 v[168:171], v8, s[8:11], s24 offen sc0 sc1
    s_mov_b32 s24, 20480
    buffer_load_dwordx4 v[20:23], v8, s[8:11], s24 offen sc0 sc1
    s_mov_b32 s24, 45056
    buffer_load_dwordx4 v[24:27], v8, s[8:11], s24 offen sc0 sc1
    s_mov_b32 s24, 69632
    buffer_load_dwordx4 v[28:31], v8, s[8:11], s24 offen sc0 sc1
    s_mov_b32 s24, 94208
    buffer_load_dwordx4 v[32:35], v8, s[8:11], s24 offen sc0 sc1
    s_mov_b32 s24, 118784
    buffer_load_dwordx4 v[36:39], v8, s[8:11], s24 offen sc0 sc1
    s_mov_b32 s24, 143360
    buffer_load_dwordx4 v[40:43], v8, s[8:11], s24 offen sc0 sc1
    s_mov_b32 s24, 167936
    buffer_load_dwordx4 v[44:47], v8, s[8:11], s24 offen sc0 sc1
    s_mov_b32 s24, 192512
    buffer_load_dwordx4 v[48:51], v8, s[8:11], s24 offen sc0 sc1
    s_mov_b32 s24, 1753088
    buffer_load_dwordx4 v[10:13], v8, s[8:11], s24 offen sc0 sc1
    s_waitcnt vmcnt(0)
    v_add_f32 v60, v60, v64
    v_add_f32 v61, v61, v65
    v_add_f32 v62, v62, v66
    v_add_f32 v63, v63, v67
    v_add_f32 v60, v60, v68
    v_add_f32 v61, v61, v69
    v_add_f32 v62, v62, v70
    v_add_f32 v63, v63, v71
    v_add_f32 v60, v60, v72
    v_add_f32 v61, v61, v73
    v_add_f32 v62, v62, v74
    v_add_f32 v63, v63, v75
    v_add_f32 v60, v60, v76
    v_add_f32 v61, v61, v77
    v_add_f32 v62, v62, v78
    v_add_f32 v63, v63, v79
    v_add_f32 v60, v60, v80
    v_add_f32 v61, v61, v81
    v_add_f32 v62, v62, v82
    v_add_f32 v63, v63, v83
    v_add_f32 v60, v60, v84
    v_add_f32 v61, v61, v85
    v_add_f32 v62, v62, v86
    v_add_f32 v63, v63, v87
    v_add_f32 v60, v60, v88
    v_add_f32 v61, v61, v89
    v_add_f32 v62, v62, v90
    v_add_f32 v63, v63, v91
    v_add_f32 v60, v60, v92
    v_add_f32 v61, v61, v93
    v_add_f32 v62, v62, v94
    v_add_f32 v63, v63, v95
    v_add_f32 v60, v60, v96
    v_add_f32 v61, v61, v97
    v_add_f32 v62, v62, v98
    v_add_f32 v63, v63, v99
    v_add_f32 v60, v60, v100
    v_add_f32 v61, v61, v101
    v_add_f32 v62, v62, v102
    v_add_f32 v63, v63, v103
    v_add_f32 v60, v60, v104
    v_add_f32 v61, v61, v105
    v_add_f32 v62, v62, v106
    v_add_f32 v63, v63, v107
    v_add_f32 v60, v60, v108
    v_add_f32 v61, v61, v109
    v_add_f32 v62, v62, v110
    v_add_f32 v63, v63, v111
    v_add_f32 v60, v60, v112
    v_add_f32 v61, v61, v113
    v_add_f32 v62, v62, v114
    v_add_f32 v63, v63, v115
    v_add_f32 v60, v60, v116
    v_add_f32 v61, v61, v117
    v_add_f32 v62, v62, v118
    v_add_f32 v63, v63, v119
    v_add_f32 v60, v60, v120
    v_add_f32 v61, v61, v121
    v_add_f32 v62, v62, v122
    v_add_f32 v63, v63, v123
    v_add_f32 v60, v60, v124
    v_add_f32 v61, v61, v125
    v_add_f32 v62, v62, v126
    v_add_f32 v63, v63, v127
    v_add_f32 v60, v60, v128
    v_add_f32 v61, v61, v129
    v_add_f32 v62, v62, v130
    v_add_f32 v63, v63, v131
    v_add_f32 v60, v60, v132
    v_add_f32 v61, v61, v133
    v_add_f32 v62, v62, v134
    v_add_f32 v63, v63, v135
    v_add_f32 v60, v60, v136
    v_add_f32 v61, v61, v137
    v_add_f32 v62, v62, v138
    v_add_f32 v63, v63, v139
    v_add_f32 v60, v60, v140
    v_add_f32 v61, v61, v141
    v_add_f32 v62, v62, v142
    v_add_f32 v63, v63, v143
    v_add_f32 v60, v60, v144
    v_add_f32 v61, v61, v145
    v_add_f32 v62, v62, v146
    v_add_f32 v63, v63, v147
    v_add_f32 v60, v60, v148
    v_add_f32 v61, v61, v149
    v_add_f32 v62, v62, v150
    v_add_f32 v63, v63, v151
    v_add_f32 v60, v60, v152
    v_add_f32 v61, v61, v153
    v_add_f32 v62, v62, v154
    v_add_f32 v63, v63, v155
    v_add_f32 v60, v60, v156
    v_add_f32 v61, v61, v157
    v_add_f32 v62, v62, v158
    v_add_f32 v63, v63, v159
    v_add_f32 v60, v60, v160
    v_add_f32 v61, v61, v161
    v_add_f32 v62, v62, v162
    v_add_f32 v63, v63, v163
    v_add_f32 v60, v60, v164
    v_add_f32 v61, v61, v165
    v_add_f32 v62, v62, v166
    v_add_f32 v63, v63, v167
    v_add_f32 v60, v60, v168
    v_add_f32 v61, v61, v169
    v_add_f32 v62, v62, v170
    v_add_f32 v63, v63, v171
    v_add_f32 v20, v20, v24
    v_add_f32 v21, v21, v25
    v_add_f32 v22, v22, v26
    v_add_f32 v23, v23, v27
    v_add_f32 v20, v20, v28
    v_add_f32 v21, v21, v29
    v_add_f32 v22, v22, v30
    v_add_f32 v23, v23, v31
    v_add_f32 v20, v20, v32
    v_add_f32 v21, v21, v33
    v_add_f32 v22, v22, v34
    v_add_f32 v23, v23, v35
    v_add_f32 v20, v20, v36
    v_add_f32 v21, v21, v37
    v_add_f32 v22, v22, v38
    v_add_f32 v23, v23, v39
    v_add_f32 v20, v20, v40
    v_add_f32 v21, v21, v41
    v_add_f32 v22, v22, v42
    v_add_f32 v23, v23, v43
    v_add_f32 v20, v20, v44
    v_add_f32 v21, v21, v45
    v_add_f32 v22, v22, v46
    v_add_f32 v23, v23, v47
    v_add_f32 v20, v20, v48
    v_add_f32 v21, v21, v49
    v_add_f32 v22, v22, v50
    v_add_f32 v23, v23, v51
    v_cvt_pk_bf16_f32 v100, v60, v60
    v_lshlrev_b32 v60, 16, v100
    v_cvt_pk_bf16_f32 v100, v20, v20
    v_lshlrev_b32 v20, 16, v100
    v_mul_f32 v60, v60, v20
    v_cvt_pk_bf16_f32 v100, v60, v60
    v_lshlrev_b32 v60, 16, v100
    v_add_f32 v10, v10, v60
    v_cvt_pk_bf16_f32 v100, v61, v61
    v_lshlrev_b32 v61, 16, v100
    v_cvt_pk_bf16_f32 v100, v21, v21
    v_lshlrev_b32 v21, 16, v100
    v_mul_f32 v61, v61, v21
    v_cvt_pk_bf16_f32 v100, v61, v61
    v_lshlrev_b32 v61, 16, v100
    v_add_f32 v11, v11, v61
    v_cvt_pk_bf16_f32 v100, v62, v62
    v_lshlrev_b32 v62, 16, v100
    v_cvt_pk_bf16_f32 v100, v22, v22
    v_lshlrev_b32 v22, 16, v100
    v_mul_f32 v62, v62, v22
    v_cvt_pk_bf16_f32 v100, v62, v62
    v_lshlrev_b32 v62, 16, v100
    v_add_f32 v12, v12, v62
    v_cvt_pk_bf16_f32 v100, v63, v63
    v_lshlrev_b32 v63, 16, v100
    v_cvt_pk_bf16_f32 v100, v23, v23
    v_lshlrev_b32 v23, 16, v100
    v_mul_f32 v63, v63, v23
    v_cvt_pk_bf16_f32 v100, v63, v63
    v_lshlrev_b32 v63, 16, v100
    v_add_f32 v13, v13, v63
    v_cvt_pk_bf16_f32 v10, v10, v11
    v_cvt_pk_bf16_f32 v11, v12, v13
    v_lshlrev_b32 v8, 3, v0
    buffer_store_dwordx2 v[10:11], v8, s[16:19], 0 offen
L_end_5:
    s_endpgm
.section .rodata,"a"
.p2align 6
.amdhsa_kernel k1_mod_kernel
  .amdhsa_next_free_vgpr 112
  .amdhsa_next_free_sgpr 40
  .amdhsa_accum_offset 112
  .amdhsa_group_segment_fixed_size 0
  .amdhsa_kernarg_size 112
  .amdhsa_user_sgpr_count 2
  .amdhsa_user_sgpr_kernarg_segment_ptr 1
  .amdhsa_system_sgpr_workgroup_id_x 1
.end_amdhsa_kernel
.p2align 6
.amdhsa_kernel k2_q_kernel
  .amdhsa_next_free_vgpr 112
  .amdhsa_next_free_sgpr 40
  .amdhsa_accum_offset 112
  .amdhsa_group_segment_fixed_size 0
  .amdhsa_kernarg_size 112
  .amdhsa_user_sgpr_count 2
  .amdhsa_user_sgpr_kernarg_segment_ptr 1
  .amdhsa_system_sgpr_workgroup_id_x 1
.end_amdhsa_kernel
.p2align 6
.amdhsa_kernel k3_attn_kernel
  .amdhsa_next_free_vgpr 184
  .amdhsa_next_free_sgpr 40
  .amdhsa_accum_offset 184
  .amdhsa_group_segment_fixed_size 0
  .amdhsa_kernarg_size 112
  .amdhsa_user_sgpr_count 2
  .amdhsa_user_sgpr_kernarg_segment_ptr 1
  .amdhsa_system_sgpr_workgroup_id_x 1
.end_amdhsa_kernel
.p2align 6
.amdhsa_kernel k4_wo_kernel
  .amdhsa_next_free_vgpr 112
  .amdhsa_next_free_sgpr 40
  .amdhsa_accum_offset 112
  .amdhsa_group_segment_fixed_size 0
  .amdhsa_kernarg_size 112
  .amdhsa_user_sgpr_count 2
  .amdhsa_user_sgpr_kernarg_segment_ptr 1
  .amdhsa_system_sgpr_workgroup_id_x 1
.end_amdhsa_kernel
.p2align 6
.amdhsa_kernel k5_gu_kernel
  .amdhsa_next_free_vgpr 184
  .amdhsa_next_free_sgpr 40
  .amdhsa_accum_offset 184
  .amdhsa_group_segment_fixed_size 0
  .amdhsa_kernarg_size 112
  .amdhsa_user_sgpr_count 2
  .amdhsa_user_sgpr_kernarg_segment_ptr 1
  .amdhsa_system_sgpr_workgroup_id_x 1
.end_amdhsa_kernel
.p2align 6
.amdhsa_kernel k6_down_kernel
  .amdhsa_next_free_vgpr 184
  .amdhsa_next_free_sgpr 40
  .amdhsa_accum_offset 184
  .amdhsa_group_segment_fixed_size 0
  .amdhsa_kernarg_size 112
  .amdhsa_user_sgpr_count 2
  .amdhsa_user_sgpr_kernarg_segment_ptr 1
  .amdhsa_system_sgpr_workgroup_id_x 1
.end_amdhsa_kernel
```
